```python
import torch

def _softmax(x, axis=-1):
    return torch.softmax(x, dim=axis)
def _gelu(x):
    return torch.nn.functional.gelu(x, approximate="tanh")
def _silu(x):
    return torch.nn.functional.silu(x)
def _sigmoid(x):
    return torch.sigmoid(x)
def _layernorm(x, axis=-1, eps=1e-5):
    m = x.mean(dim=axis, keepdim=True)
    v = x.var(dim=axis, keepdim=True, unbiased=False)
    return (x - m) / torch.sqrt(v + eps)
def _scatter_add(tgt, idx, src, axis=0):
    return tgt.clone().index_add_(axis, idx, src)
def _segment_sum(src, seg, n):
    out = torch.zeros((n,) + src.shape[1:], dtype=src.dtype)
    return out.index_add_(0, seg, src)
def _pad(x, pw):
    flat = tuple(v for pair in reversed(pw) for v in pair)
    return torch.nn.functional.pad(x, flat)

kernel_name = 'standalone__mha_block_cached__near_ridge'

def setup_inputs():

    _w = (lambda a: (lambda t: t.to(torch.bfloat16) if t.is_floating_point() else t)(torch.as_tensor(a)))
    B, Sq, D = 16, 48, 1024
    H, Sk, Dh = 32, 48, 128
    return {
        "x": _w((lambda *s: torch.randn(*s, dtype=torch.bfloat16) * 0.8)(B, Sq, D)),
        "k_cache": _w((lambda *s: torch.randn(*s, dtype=torch.bfloat16) * 0.8)(B, H, Sk, Dh)),
        "v_cache": _w((lambda *s: torch.randn(*s, dtype=torch.bfloat16) * 0.05)(B, H, Sk, Dh)),
        "wq": _w((lambda *s: torch.randn(*s, dtype=torch.bfloat16) * 0.8)(D, H * Dh) * (D ** -0.5)),
        "wo": _w((lambda *s: torch.randn(*s, dtype=torch.bfloat16) * 0.05)(H * Dh, D) * ((H * Dh) ** -0.5)),
    }

def reference(x, k_cache, v_cache, wq, wo):
    B, Sq, D = x.shape
    H, Dh = 32, 128
    q = (lambda x, *d: x.permute(*d))((x @ wq).reshape(B, Sq, H, Dh), 0, 2, 1, 3)
    scores = torch.einsum("bhqd,bhkd->bhqk", q, k_cache) * (Dh ** -0.5)
    p = _softmax(scores, axis=-1)
    o = torch.einsum("bhqk,bhkd->bhqd", p, v_cache)
    return (lambda x, *d: x.permute(*d))(o, 0, 2, 1, 3).reshape(B, Sq, H * Dh) @ wo
```

```asm
; @launch grid=(256,1,1) block=(512,1,1) lds=163840
.amdgcn_target "amdgcn-amd-amdhsa--gfx950"
.text
.globl standalone__mha_block_cached__near_ridge_kernel
.p2align 8
.type standalone__mha_block_cached__near_ridge_kernel,@function
standalone__mha_block_cached__near_ridge_kernel:
  s_cmp_ge_u32 s2, 256
  s_cbranch_scc1 L_end
  s_load_dwordx16 s[4:19], s[0:1], 0
  s_getpc_b64 s[96:97]
L_pc:
  s_lshr_b32 s45, s2, 3
  s_lshl_b32 s45, s45, 10
  v_lshl_add_u32 v30, v0, 1, s45
  s_sub_u32 s96, s96, L_pc-standalone__mha_block_cached__near_ridge_kernel
  s_subb_u32 s97, s97, 0
  v_min_u32 v30, L_codeend-standalone__mha_block_cached__near_ridge_kernel-2, v30
  v_mov_b32 v31, s97
  v_add_co_u32 v30, vcc, s96, v30
  s_nop 1
  v_addc_co_u32 v31, vcc, 0, v31, vcc
  global_load_ushort v253, v[30:31], off
  v_lshrrev_b32 v1, 6, v0
  v_and_b32 v0, 63, v0
  v_readfirstlane_b32 s36, v1
  v_lshrrev_b32 v24, 4, v0
  v_and_b32 v25, 15, v0
  s_and_b32 s45, s2, 7
  s_lshr_b32 s38, s2, 3
  s_and_b32 s46, s38, 3
  s_lshr_b32 s38, s38, 2
  s_lshl_b32 s37, s45, 2
  s_add_u32 s37, s37, s46
  s_lshr_b32 s39, s37, 3
  s_and_b32 s40, s37, 7
  s_mov_b32 s98, 0x27d59e37
  s_mov_b32 s99, 0xeb2f79b9
  s_mov_b32 s100, 0x165785eb
  s_mov_b32 s101, 0x67b4c2b2
  s_cmp_ge_u32 s36, 4
  s_cbranch_scc0 L_cons1
  s_sub_u32 s57, s36, 4
  s_lshl_b32 s54, s38, 1
  s_mul_i32 s47, s45, 2
  s_add_u32 s54, s54, s47
  s_and_b32 s54, s54, 15
  v_lshrrev_b32 v30, 3, v0
  v_and_b32 v31, 7, v0
  s_mul_i32 s49, s57, 3
  s_add_u32 s45, s49, 0
  s_and_b32 s46, s45, 1
  s_lshl_b32 s46, s46, 2
  v_or_b32 v26, s46, v24
  v_xor_b32 v26, v26, v31
  v_lshlrev_b32 v26, 4, v26
  s_lshl_b32 s45, s45, 14
  v_lshlrev_b32 v27, 11, v30
  v_add3_u32 v1, v26, v27, s45
  s_add_u32 s45, s49, 1
  s_and_b32 s46, s45, 1
  s_lshl_b32 s46, s46, 2
  v_or_b32 v26, s46, v24
  v_xor_b32 v26, v26, v31
  v_lshlrev_b32 v26, 4, v26
  s_lshl_b32 s45, s45, 14
  s_sub_u32 s45, s45, 1024
  v_lshlrev_b32 v27, 11, v30
  v_add3_u32 v2, v26, v27, s45
  s_add_u32 s45, s49, 2
  s_and_b32 s46, s45, 1
  s_lshl_b32 s46, s46, 2
  v_or_b32 v26, s46, v24
  v_xor_b32 v26, v26, v31
  v_lshlrev_b32 v26, 4, v26
  s_lshl_b32 s45, s45, 14
  s_sub_u32 s45, s45, 2048
  v_lshlrev_b32 v27, 11, v30
  v_add3_u32 v3, v26, v27, s45
  v_or_b32 v28, 0, v24
  v_lshlrev_b32 v28, 1, v28
  v_xor_b32 v28, v28, v25
  v_lshlrev_b32 v28, 4, v28
  v_or_b32 v29, 4, v24
  v_lshlrev_b32 v29, 1, v29
  v_xor_b32 v29, v29, v25
  v_lshlrev_b32 v29, 4, v29
  v_lshlrev_b32 v27, 13, v24
  s_lshl_b32 s45, s57, 17
  v_add3_u32 v4, v28, v27, s45
  s_lshl_b32 s45, s57, 17
  s_add_u32 s45, s45, 31744
  v_add3_u32 v5, v28, v27, s45
  s_lshl_b32 s45, s57, 17
  s_add_u32 s45, s45, 63488
  v_add3_u32 v6, v29, v27, s45
  s_lshl_b32 s45, s57, 17
  s_add_u32 s45, s45, 95232
  v_add3_u32 v7, v29, v27, s45
  s_mul_i32 s43, s57, 3072
  s_lshl_b32 s44, s57, 12
  s_add_u32 s44, s44, 12288
  s_lshl_b32 s41, s54, 7
  s_lshl_b32 s42, s54, 19
  s_waitcnt lgkmcnt(0)
  s_mul_i32 s45, s38, 196608
  s_add_u32 s20, s4, s45
  s_addc_u32 s21, s5, 0
  s_sub_u32 s22, 1572864, s45
  s_mov_b32 s23, 0x20000
  s_lshl_b32 s45, s37, 8
  s_add_u32 s24, s10, s45
  s_addc_u32 s25, s11, 0
  s_sub_u32 s26, 8388608, s45
  s_mov_b32 s27, 0x20000
  s_add_u32 m0, s43, 0
  s_nop 0
  buffer_load_dwordx4 v1, s[20:23], s41 offen lds
  buffer_load_dwordx4 v2, s[20:23], s41 offen offset:1024 lds
  buffer_load_dwordx4 v3, s[20:23], s41 offen offset:2048 lds
  s_add_u32 m0, s44, 0
  s_nop 0
  buffer_load_dwordx4 v4, s[24:27], s42 offen lds
  buffer_load_dwordx4 v5, s[24:27], s42 offen offset:1024 lds
  buffer_load_dwordx4 v6, s[24:27], s42 offen offset:2048 lds
  buffer_load_dwordx4 v7, s[24:27], s42 offen offset:3072 lds
  s_add_u32 s41, s41, 128
  s_and_b32 s41, s41, 2047
  s_lshl_b32 s42, s41, 12
  s_add_u32 m0, s43, 28672
  s_nop 0
  buffer_load_dwordx4 v1, s[20:23], s41 offen lds
  buffer_load_dwordx4 v2, s[20:23], s41 offen offset:1024 lds
  buffer_load_dwordx4 v3, s[20:23], s41 offen offset:2048 lds
  s_add_u32 m0, s44, 28672
  s_nop 0
  buffer_load_dwordx4 v4, s[24:27], s42 offen lds
  buffer_load_dwordx4 v5, s[24:27], s42 offen offset:1024 lds
  buffer_load_dwordx4 v6, s[24:27], s42 offen offset:2048 lds
  buffer_load_dwordx4 v7, s[24:27], s42 offen offset:3072 lds
  s_add_u32 s41, s41, 128
  s_and_b32 s41, s41, 2047
  s_lshl_b32 s42, s41, 12
  s_add_u32 m0, s43, 57344
  s_nop 0
  buffer_load_dwordx4 v1, s[20:23], s41 offen lds
  buffer_load_dwordx4 v2, s[20:23], s41 offen offset:1024 lds
  buffer_load_dwordx4 v3, s[20:23], s41 offen offset:2048 lds
  s_add_u32 m0, s44, 57344
  s_nop 0
  buffer_load_dwordx4 v4, s[24:27], s42 offen lds
  buffer_load_dwordx4 v5, s[24:27], s42 offen offset:1024 lds
  buffer_load_dwordx4 v6, s[24:27], s42 offen offset:2048 lds
  buffer_load_dwordx4 v7, s[24:27], s42 offen offset:3072 lds
  s_add_u32 s41, s41, 128
  s_and_b32 s41, s41, 2047
  s_lshl_b32 s42, s41, 12
  s_mov_b32 s32, s18
  s_mov_b32 s33, s19
  s_mov_b32 s34, 22020096
  s_mov_b32 s35, 0x20000
  s_mov_b32 s92, s16
  s_mov_b32 s93, s17
  s_mov_b32 s94, 256
  s_mov_b32 s95, 0x20000
  s_mov_b32 s88, s14
  s_mov_b32 s89, s15
  s_mov_b32 s90, 1572864
  s_mov_b32 s91, 0x20000
  s_lshl_b32 s45, s39, 21
  s_lshl_b32 s46, s40, 8
  s_add_u32 s45, s45, s46
  s_add_u32 s84, s12, s45
  s_addc_u32 s85, s13, 0
  s_sub_u32 s86, 8388608, s45
  s_mov_b32 s87, 0x20000
  v_lshlrev_b32 v27, 11, v24
  s_lshr_b32 s46, s57, 1
  s_lshl_b32 s46, s46, 5
  s_and_b32 s47, s57, 1
  s_lshl_b32 s47, s47, 3
  s_add_u32 s46, s46, s47
  s_lshl_b32 s46, s46, 11
  s_add_u32 s45, s46, 0
  v_add3_u32 v8, v28, v27, s45
  s_add_u32 s45, s46, 31744
  v_add3_u32 v9, v28, v27, s45
  s_add_u32 s45, s46, 6144
  v_add3_u32 v10, v29, v27, s45
  s_add_u32 s45, s46, 37888
  v_add3_u32 v11, v29, v27, s45
  s_cmp_ge_u32 s36, 3
  s_cselect_b32 s52, 1, 0
  s_mul_i32 s53, s52, 3
  s_sub_u32 s53, s36, s53
  s_mul_i32 s45, s52, 28672
  s_lshl_b32 s46, s53, 12
  s_add_u32 s45, s45, s46
  s_add_u32 s45, s45, 57344
  v_lshl_add_u32 v240, v0, 4, s45
  s_mul_i32 s45, s52, 12288
  s_add_u32 s45, s45, 114688
  v_xor_b32 v241, v24, v25
  v_lshlrev_b32 v241, 4, v241
  v_lshl_add_u32 v241, v25, 8, v241
  v_add_u32 v241, s45, v241
  v_xor_b32 v242, 64, v241
  v_xor_b32 v243, 0x80, v241
  v_xor_b32 v244, 0xc0, v241
  v_lshrrev_b32 v26, 2, v25
  v_and_b32 v27, 3, v0
  v_lshl_add_u32 v28, v24, 2, v26
  v_lshlrev_b32 v28, 8, v28
  v_and_b32 v29, 1, v27
  v_lshl_add_u32 v28, v29, 3, v28
  v_and_b32 v29, 1, v24
  v_lshlrev_b32 v29, 3, v29
  v_lshl_add_u32 v29, v26, 1, v29
  v_lshrrev_b32 v27, 1, v27
  v_xor_b32 v27, v27, v29
  v_lshl_add_u32 v28, v27, 4, v28
  s_add_u32 s45, s45, 24576
  v_add_u32 v245, s45, v28
  v_xor_b32 v246, 32, v245
  v_xor_b32 v247, 64, v245
  v_xor_b32 v248, 96, v245
  v_xor_b32 v249, 128, v245
  v_xor_b32 v250, 160, v245
  v_xor_b32 v251, 192, v245
  v_xor_b32 v252, 224, v245
  s_waitcnt vmcnt(14)
  s_barrier
  s_add_u32 m0, s43, 86016
  s_nop 0
  buffer_load_dwordx4 v1, s[20:23], s41 offen lds
  buffer_load_dwordx4 v2, s[20:23], s41 offen offset:1024 lds
  buffer_load_dwordx4 v3, s[20:23], s41 offen offset:2048 lds
  s_add_u32 m0, s44, 86016
  s_nop 0
  buffer_load_dwordx4 v4, s[24:27], s42 offen lds
  buffer_load_dwordx4 v5, s[24:27], s42 offen offset:1024 lds
  buffer_load_dwordx4 v6, s[24:27], s42 offen offset:2048 lds
  buffer_load_dwordx4 v7, s[24:27], s42 offen offset:3072 lds
  s_add_u32 s41, s41, 128
  s_and_b32 s41, s41, 2047
  s_lshl_b32 s42, s41, 12
  s_waitcnt vmcnt(14)
  s_barrier
  s_add_u32 m0, s43, 0
  s_nop 0
  buffer_load_dwordx4 v1, s[20:23], s41 offen lds
  buffer_load_dwordx4 v2, s[20:23], s41 offen offset:1024 lds
  buffer_load_dwordx4 v3, s[20:23], s41 offen offset:2048 lds
  s_add_u32 m0, s44, 0
  s_nop 0
  buffer_load_dwordx4 v4, s[24:27], s42 offen lds
  buffer_load_dwordx4 v5, s[24:27], s42 offen offset:1024 lds
  buffer_load_dwordx4 v6, s[24:27], s42 offen offset:2048 lds
  buffer_load_dwordx4 v7, s[24:27], s42 offen offset:3072 lds
  s_add_u32 s41, s41, 128
  s_and_b32 s41, s41, 2047
  s_lshl_b32 s42, s41, 12
  s_waitcnt vmcnt(14)
  s_barrier
  s_add_u32 m0, s43, 28672
  s_nop 0
  buffer_load_dwordx4 v1, s[20:23], s41 offen lds
  buffer_load_dwordx4 v2, s[20:23], s41 offen offset:1024 lds
  buffer_load_dwordx4 v3, s[20:23], s41 offen offset:2048 lds
  s_add_u32 m0, s44, 28672
  s_nop 0
  buffer_load_dwordx4 v4, s[24:27], s42 offen lds
  buffer_load_dwordx4 v5, s[24:27], s42 offen offset:1024 lds
  buffer_load_dwordx4 v6, s[24:27], s42 offen offset:2048 lds
  buffer_load_dwordx4 v7, s[24:27], s42 offen offset:3072 lds
  s_add_u32 s41, s41, 128
  s_and_b32 s41, s41, 2047
  s_lshl_b32 s42, s41, 12
  s_waitcnt vmcnt(14)
  s_barrier
  s_add_u32 m0, s43, 57344
  s_nop 0
  buffer_load_dwordx4 v1, s[20:23], s41 offen lds
  buffer_load_dwordx4 v2, s[20:23], s41 offen offset:1024 lds
  buffer_load_dwordx4 v3, s[20:23], s41 offen offset:2048 lds
  s_add_u32 m0, s44, 57344
  s_nop 0
  buffer_load_dwordx4 v4, s[24:27], s42 offen lds
  buffer_load_dwordx4 v5, s[24:27], s42 offen offset:1024 lds
  buffer_load_dwordx4 v6, s[24:27], s42 offen offset:2048 lds
  buffer_load_dwordx4 v7, s[24:27], s42 offen offset:3072 lds
  s_add_u32 s41, s41, 128
  s_and_b32 s41, s41, 2047
  s_lshl_b32 s42, s41, 12
  s_waitcnt vmcnt(14)
  s_barrier
  s_add_u32 m0, s43, 86016
  s_nop 0
  buffer_load_dwordx4 v1, s[20:23], s41 offen lds
  buffer_load_dwordx4 v2, s[20:23], s41 offen offset:1024 lds
  buffer_load_dwordx4 v3, s[20:23], s41 offen offset:2048 lds
  s_add_u32 m0, s44, 86016
  s_nop 0
  buffer_load_dwordx4 v4, s[24:27], s42 offen lds
  buffer_load_dwordx4 v5, s[24:27], s42 offen offset:1024 lds
  buffer_load_dwordx4 v6, s[24:27], s42 offen offset:2048 lds
  buffer_load_dwordx4 v7, s[24:27], s42 offen offset:3072 lds
  s_add_u32 s41, s41, 128
  s_and_b32 s41, s41, 2047
  s_lshl_b32 s42, s41, 12
  s_waitcnt vmcnt(14)
  s_barrier
  s_add_u32 m0, s43, 0
  s_nop 0
  buffer_load_dwordx4 v1, s[20:23], s41 offen lds
  buffer_load_dwordx4 v2, s[20:23], s41 offen offset:1024 lds
  buffer_load_dwordx4 v3, s[20:23], s41 offen offset:2048 lds
  s_add_u32 m0, s44, 0
  s_nop 0
  buffer_load_dwordx4 v4, s[24:27], s42 offen lds
  buffer_load_dwordx4 v5, s[24:27], s42 offen offset:1024 lds
  buffer_load_dwordx4 v6, s[24:27], s42 offen offset:2048 lds
  buffer_load_dwordx4 v7, s[24:27], s42 offen offset:3072 lds
  s_add_u32 s41, s41, 128
  s_and_b32 s41, s41, 2047
  s_lshl_b32 s42, s41, 12
  s_waitcnt vmcnt(14)
  s_barrier
  s_add_u32 m0, s43, 28672
  s_nop 0
  buffer_load_dwordx4 v1, s[20:23], s41 offen lds
  buffer_load_dwordx4 v2, s[20:23], s41 offen offset:1024 lds
  buffer_load_dwordx4 v3, s[20:23], s41 offen offset:2048 lds
  s_add_u32 m0, s44, 28672
  s_nop 0
  buffer_load_dwordx4 v4, s[24:27], s42 offen lds
  buffer_load_dwordx4 v5, s[24:27], s42 offen offset:1024 lds
  buffer_load_dwordx4 v6, s[24:27], s42 offen offset:2048 lds
  buffer_load_dwordx4 v7, s[24:27], s42 offen offset:3072 lds
  s_add_u32 s41, s41, 128
  s_and_b32 s41, s41, 2047
  s_lshl_b32 s42, s41, 12
  s_waitcnt vmcnt(14)
  s_barrier
  s_add_u32 m0, s43, 57344
  s_nop 0
  buffer_load_dwordx4 v1, s[20:23], s41 offen lds
  buffer_load_dwordx4 v2, s[20:23], s41 offen offset:1024 lds
  buffer_load_dwordx4 v3, s[20:23], s41 offen offset:2048 lds
  s_add_u32 m0, s44, 57344
  s_nop 0
  buffer_load_dwordx4 v4, s[24:27], s42 offen lds
  buffer_load_dwordx4 v5, s[24:27], s42 offen offset:1024 lds
  buffer_load_dwordx4 v6, s[24:27], s42 offen offset:2048 lds
  buffer_load_dwordx4 v7, s[24:27], s42 offen offset:3072 lds
  s_add_u32 s41, s41, 128
  s_and_b32 s41, s41, 2047
  s_lshl_b32 s42, s41, 12
  s_waitcnt vmcnt(14)
  s_barrier
  s_add_u32 m0, s43, 86016
  s_nop 0
  buffer_load_dwordx4 v1, s[20:23], s41 offen lds
  buffer_load_dwordx4 v2, s[20:23], s41 offen offset:1024 lds
  buffer_load_dwordx4 v3, s[20:23], s41 offen offset:2048 lds
  s_add_u32 m0, s44, 86016
  s_nop 0
  buffer_load_dwordx4 v4, s[24:27], s42 offen lds
  buffer_load_dwordx4 v5, s[24:27], s42 offen offset:1024 lds
  buffer_load_dwordx4 v6, s[24:27], s42 offen offset:2048 lds
  buffer_load_dwordx4 v7, s[24:27], s42 offen offset:3072 lds
  s_add_u32 s41, s41, 128
  s_and_b32 s41, s41, 2047
  s_lshl_b32 s42, s41, 12
  s_waitcnt vmcnt(14)
  s_barrier
  s_add_u32 m0, s43, 0
  s_nop 0
  buffer_load_dwordx4 v1, s[20:23], s41 offen lds
  buffer_load_dwordx4 v2, s[20:23], s41 offen offset:1024 lds
  buffer_load_dwordx4 v3, s[20:23], s41 offen offset:2048 lds
  s_add_u32 m0, s44, 0
  s_nop 0
  buffer_load_dwordx4 v4, s[24:27], s42 offen lds
  buffer_load_dwordx4 v5, s[24:27], s42 offen offset:1024 lds
  buffer_load_dwordx4 v6, s[24:27], s42 offen offset:2048 lds
  buffer_load_dwordx4 v7, s[24:27], s42 offen offset:3072 lds
  s_add_u32 s41, s41, 128
  s_and_b32 s41, s41, 2047
  s_lshl_b32 s42, s41, 12
  s_waitcnt vmcnt(14)
  s_barrier
  s_add_u32 m0, s43, 28672
  s_nop 0
  buffer_load_dwordx4 v1, s[20:23], s41 offen lds
  buffer_load_dwordx4 v2, s[20:23], s41 offen offset:1024 lds
  buffer_load_dwordx4 v3, s[20:23], s41 offen offset:2048 lds
  s_add_u32 m0, s44, 28672
  s_nop 0
  buffer_load_dwordx4 v4, s[24:27], s42 offen lds
  buffer_load_dwordx4 v5, s[24:27], s42 offen offset:1024 lds
  buffer_load_dwordx4 v6, s[24:27], s42 offen offset:2048 lds
  buffer_load_dwordx4 v7, s[24:27], s42 offen offset:3072 lds
  s_add_u32 s41, s41, 128
  s_and_b32 s41, s41, 2047
  s_lshl_b32 s42, s41, 12
  s_waitcnt vmcnt(14)
  s_barrier
  s_add_u32 m0, s43, 57344
  s_nop 0
  buffer_load_dwordx4 v1, s[20:23], s41 offen lds
  buffer_load_dwordx4 v2, s[20:23], s41 offen offset:1024 lds
  buffer_load_dwordx4 v3, s[20:23], s41 offen offset:2048 lds
  s_add_u32 m0, s44, 57344
  s_nop 0
  buffer_load_dwordx4 v4, s[24:27], s42 offen lds
  buffer_load_dwordx4 v5, s[24:27], s42 offen offset:1024 lds
  buffer_load_dwordx4 v6, s[24:27], s42 offen offset:2048 lds
  buffer_load_dwordx4 v7, s[24:27], s42 offen offset:3072 lds
  s_add_u32 s41, s41, 128
  s_and_b32 s41, s41, 2047
  s_lshl_b32 s42, s41, 12
  s_waitcnt vmcnt(14)
  s_barrier
  s_add_u32 m0, s43, 86016
  s_nop 0
  buffer_load_dwordx4 v1, s[20:23], s41 offen lds
  buffer_load_dwordx4 v2, s[20:23], s41 offen offset:1024 lds
  buffer_load_dwordx4 v3, s[20:23], s41 offen offset:2048 lds
  s_add_u32 m0, s44, 86016
  s_nop 0
  buffer_load_dwordx4 v4, s[24:27], s42 offen lds
  buffer_load_dwordx4 v5, s[24:27], s42 offen offset:1024 lds
  buffer_load_dwordx4 v6, s[24:27], s42 offen offset:2048 lds
  buffer_load_dwordx4 v7, s[24:27], s42 offen offset:3072 lds
  s_add_u32 s41, s41, 128
  s_and_b32 s41, s41, 2047
  s_lshl_b32 s42, s41, 12
  s_waitcnt vmcnt(14)
  s_barrier
  v_mov_b32 v26, 0
  buffer_load_dwordx2 v[140:141], v26, s[92:95], 0 offen sc1
  s_waitcnt vmcnt(8)
  s_barrier
  s_lshl_b32 s45, s39, 21
  s_and_b32 s46, s40, 4
  s_lshl_b32 s46, s46, 8
  s_add_u32 s45, s45, s46
  s_add_u32 s28, s12, s45
  s_addc_u32 s29, s13, 0
  s_sub_u32 s30, 8388608, s45
  s_mov_b32 s31, 0x20000
  s_lshl_b32 s45, s38, 2
  s_and_b32 s46, s40, 3
  s_add_u32 s45, s45, s46
  s_lshl_b32 s45, s45, 16
  s_mul_i32 s46, s57, 16384
  s_add_u32 s45, s45, s46
  v_lshlrev_b32 v26, 4, v0
  buffer_load_dwordx4 v[12:15], v26, s[28:31], s45 offen
  s_add_u32 s45, s45, 2048
  buffer_load_dwordx4 v[12:15], v26, s[28:31], s45 offen
  s_add_u32 s45, s45, 2048
  buffer_load_dwordx4 v[12:15], v26, s[28:31], s45 offen
  s_add_u32 s45, s45, 2048
  buffer_load_dwordx4 v[12:15], v26, s[28:31], s45 offen
  s_add_u32 s45, s45, 2048
  buffer_load_dwordx4 v[12:15], v26, s[28:31], s45 offen
  s_add_u32 s45, s45, 2048
  buffer_load_dwordx4 v[12:15], v26, s[28:31], s45 offen
  s_add_u32 s45, s45, 2048
  buffer_load_dwordx4 v[12:15], v26, s[28:31], s45 offen
  s_add_u32 s45, s45, 2048
  buffer_load_dwordx4 v[12:15], v26, s[28:31], s45 offen
  s_cmp_ge_u32 s36, 6
  s_cbranch_scc1 L_nokv13
  ds_read_b128 v[144:147], v241
  ds_read_b128 v[148:151], v242
  ds_read_b128 v[152:155], v243
  ds_read_b128 v[156:159], v244
  ds_read_b128 v[160:163], v241 offset:4096
  ds_read_b128 v[164:167], v242 offset:4096
  ds_read_b128 v[168:171], v243 offset:4096
  ds_read_b128 v[172:175], v244 offset:4096
  ds_read_b128 v[176:179], v241 offset:8192
  ds_read_b128 v[180:183], v242 offset:8192
  ds_read_b128 v[184:187], v243 offset:8192
  ds_read_b128 v[188:191], v244 offset:8192
L_nokv13:
  s_waitcnt vmcnt(9)
  s_barrier
  s_cmp_ge_u32 s36, 6
  s_cbranch_scc1 L_nokv14
  ds_read_b64_tr_b16 v[192:193], v245
  ds_read_b64_tr_b16 v[194:195], v245 offset:4096
  ds_read_b64_tr_b16 v[224:225], v245 offset:8192
  ds_read_b64_tr_b16 v[196:197], v246
  ds_read_b64_tr_b16 v[198:199], v246 offset:4096
  ds_read_b64_tr_b16 v[226:227], v246 offset:8192
  ds_read_b64_tr_b16 v[200:201], v247
  ds_read_b64_tr_b16 v[202:203], v247 offset:4096
  ds_read_b64_tr_b16 v[228:229], v247 offset:8192
  ds_read_b64_tr_b16 v[204:205], v248
  ds_read_b64_tr_b16 v[206:207], v248 offset:4096
  ds_read_b64_tr_b16 v[230:231], v248 offset:8192
L_nokv14:
  s_waitcnt lgkmcnt(0)
  s_barrier
  s_mov_b64 exec, 1
  v_mov_b32 v26, 114688
  v_mov_b32 v27, 0
  ds_write_b32 v26, v27
  s_mov_b64 exec, -1
  s_cmp_ge_u32 s36, 6
  s_cbranch_scc1 L_nokv15
  ds_read_b64_tr_b16 v[208:209], v249
  ds_read_b64_tr_b16 v[210:211], v249 offset:4096
  ds_read_b64_tr_b16 v[232:233], v249 offset:8192
  ds_read_b64_tr_b16 v[212:213], v250
  ds_read_b64_tr_b16 v[214:215], v250 offset:4096
  ds_read_b64_tr_b16 v[234:235], v250 offset:8192
  ds_read_b64_tr_b16 v[216:217], v251
  ds_read_b64_tr_b16 v[218:219], v251 offset:4096
  ds_read_b64_tr_b16 v[236:237], v251 offset:8192
  ds_read_b64_tr_b16 v[220:221], v252
  ds_read_b64_tr_b16 v[222:223], v252 offset:4096
  ds_read_b64_tr_b16 v[238:239], v252 offset:8192
L_nokv15:
  s_waitcnt vmcnt(8)
  s_mov_b32 s55, 32768
Ln_l:
  v_readfirstlane_b32 s58, v140
  v_readfirstlane_b32 s59, v141
  s_nop 0
  s_cmp_lg_u32 s59, 0
  s_cbranch_scc1 Lnd_l
  s_sub_u32 s55, s55, 1
  s_cmp_eq_u32 s55, 0
  s_cbranch_scc1 Lnd_l
  s_sleep 2
  v_mov_b32 v26, 0
  buffer_load_dwordx2 v[140:141], v26, s[92:95], 0 offen sc1
  s_waitcnt vmcnt(0)
  s_branch Ln_l
Lnd_l:
  v_mov_b32 v254, s58
  s_waitcnt lgkmcnt(0)
  s_branch L_bq
L_cons1:
  s_and_b32 s50, s36, 1
  s_lshr_b32 s51, s36, 1
  v_lshrrev_b32 v26, 1, v25
  v_xor_b32 v26, v26, v24
  v_lshlrev_b32 v26, 4, v26
  s_mul_i32 s45, s50, 6144
  v_lshl_add_u32 v27, v25, 7, s45
  v_add_u32 v12, v26, v27
  v_xor_b32 v13, 64, v12
  v_add_u32 v14, 57344, v12
  v_add_u32 v15, 57344, v13
  v_lshrrev_b32 v26, 2, v25
  v_and_b32 v27, 3, v0
  v_lshl_add_u32 v28, v24, 3, v26
  v_lshlrev_b32 v28, 8, v28
  v_and_b32 v29, 1, v27
  v_lshl_add_u32 v28, v29, 3, v28
  v_and_b32 v29, 1, v24
  v_lshlrev_b32 v29, 3, v29
  v_lshl_add_u32 v29, v26, 1, v29
  v_lshrrev_b32 v27, 1, v27
  s_lshl_b32 s45, s51, 3
  v_or_b32 v27, s45, v27
  v_or_b32 v26, 0, v27
  v_xor_b32 v26, v26, v29
  v_lshl_add_u32 v16, v26, 4, v28
  v_add_u32 v20, 57344, v16
  v_or_b32 v26, 2, v27
  v_xor_b32 v26, v26, v29
  v_lshl_add_u32 v17, v26, 4, v28
  v_add_u32 v21, 57344, v17
  v_or_b32 v26, 4, v27
  v_xor_b32 v26, v26, v29
  v_lshl_add_u32 v18, v26, 4, v28
  v_add_u32 v22, 57344, v18
  v_or_b32 v26, 6, v27
  v_xor_b32 v26, v26, v29
  v_lshl_add_u32 v19, v26, 4, v28
  v_add_u32 v23, 57344, v19
  s_cmp_ge_u32 s36, 3
  s_cselect_b32 s52, 1, 0
  s_mul_i32 s53, s52, 3
  s_sub_u32 s53, s36, s53
  s_mul_i32 s45, s52, 28672
  s_lshl_b32 s46, s53, 12
  s_add_u32 s45, s45, s46
  s_add_u32 s45, s45, 57344
  v_lshl_add_u32 v240, v0, 4, s45
  s_mul_i32 s45, s52, 12288
  s_add_u32 s45, s45, 114688
  v_xor_b32 v241, v24, v25
  v_lshlrev_b32 v241, 4, v241
  v_lshl_add_u32 v241, v25, 8, v241
  v_add_u32 v241, s45, v241
  v_xor_b32 v242, 64, v241
  v_xor_b32 v243, 0x80, v241
  v_xor_b32 v244, 0xc0, v241
  v_lshrrev_b32 v26, 2, v25
  v_and_b32 v27, 3, v0
  v_lshl_add_u32 v28, v24, 2, v26
  v_lshlrev_b32 v28, 8, v28
  v_and_b32 v29, 1, v27
  v_lshl_add_u32 v28, v29, 3, v28
  v_and_b32 v29, 1, v24
  v_lshlrev_b32 v29, 3, v29
  v_lshl_add_u32 v29, v26, 1, v29
  v_lshrrev_b32 v27, 1, v27
  v_xor_b32 v27, v27, v29
  v_lshl_add_u32 v28, v27, 4, v28
  s_add_u32 s45, s45, 24576
  v_add_u32 v245, s45, v28
  v_xor_b32 v246, 32, v245
  v_xor_b32 v247, 64, v245
  v_xor_b32 v248, 96, v245
  v_xor_b32 v249, 128, v245
  v_xor_b32 v250, 160, v245
  v_xor_b32 v251, 192, v245
  v_xor_b32 v252, 224, v245
  s_cmp_ge_u32 s36, 2
  s_cbranch_scc1 L_kvV
  v_or_b32 v26, 0, v24
  v_xor_b32 v26, v26, v25
  v_lshlrev_b32 v26, 4, v26
  v_lshl_add_u32 v8, v24, 8, v26
  v_or_b32 v26, 4, v24
  v_xor_b32 v26, v26, v25
  v_lshlrev_b32 v26, 4, v26
  v_lshl_add_u32 v9, v24, 8, v26
  v_or_b32 v26, 8, v24
  v_xor_b32 v26, v26, v25
  v_lshlrev_b32 v26, 4, v26
  v_lshl_add_u32 v10, v24, 8, v26
  v_or_b32 v26, 12, v24
  v_xor_b32 v26, v26, v25
  v_lshlrev_b32 v26, 4, v26
  v_lshl_add_u32 v11, v24, 8, v26
  s_branch L_kvdone
L_kvV:
  v_or_b32 v26, 0, v24
  v_lshlrev_b32 v26, 1, v26
  v_xor_b32 v26, v26, v25
  v_lshlrev_b32 v26, 4, v26
  v_lshl_add_u32 v8, v24, 8, v26
  v_or_b32 v26, 4, v24
  v_lshlrev_b32 v26, 1, v26
  v_xor_b32 v26, v26, v25
  v_lshlrev_b32 v26, 4, v26
  v_lshl_add_u32 v9, v24, 8, v26
  v_or_b32 v26, 0, v24
  v_lshlrev_b32 v26, 1, v26
  v_xor_b32 v26, v26, v25
  v_lshlrev_b32 v26, 4, v26
  v_lshl_add_u32 v10, v24, 8, v26
  v_or_b32 v26, 4, v24
  v_lshlrev_b32 v26, 1, v26
  v_xor_b32 v26, v26, v25
  v_lshlrev_b32 v26, 4, v26
  v_lshl_add_u32 v11, v24, 8, v26
L_kvdone:
  s_mul_i32 s48, s36, 12288
  s_add_u32 s48, s48, 114688
  s_waitcnt lgkmcnt(0)
  s_lshl_b32 s45, s38, 1
  s_add_u32 s45, s45, s50
  s_lshl_b32 s45, s45, 5
  s_add_u32 s45, s45, s37
  s_mul_i32 s45, s45, 12288
  s_cmp_ge_u32 s36, 2
  s_cselect_b32 s46, s8, s6
  s_cselect_b32 s47, s9, s7
  s_add_u32 s28, s46, s45
  s_addc_u32 s29, s47, 0
  s_sub_u32 s30, 6291456, s45
  s_mov_b32 s31, 0x20000
  s_mov_b32 s32, s18
  s_mov_b32 s33, s19
  s_mov_b32 s34, 22020096
  s_mov_b32 s35, 0x20000
  s_mov_b32 s92, s16
  s_mov_b32 s93, s17
  s_mov_b32 s94, 256
  s_mov_b32 s95, 0x20000
  s_mov_b32 s88, s14
  s_mov_b32 s89, s15
  s_mov_b32 s90, 1572864
  s_mov_b32 s91, 0x20000
  s_lshl_b32 s45, s39, 21
  s_lshl_b32 s46, s40, 8
  s_add_u32 s45, s45, s46
  s_add_u32 s84, s12, s45
  s_addc_u32 s85, s13, 0
  s_sub_u32 s86, 8388608, s45
  s_mov_b32 s87, 0x20000
  s_and_b32 s45, s37, 3
  s_and_b32 s46, s38, 1
  s_lshl_b32 s46, s46, 2
  s_add_u32 s45, s45, s46
  s_lshr_b32 s46, s37, 2
  s_add_u32 s45, s45, s46
  s_and_b32 s45, s45, 7
  s_lshl_b32 s45, s45, 2
  s_lshr_b32 s46, 0x12345678, s45
  s_lshr_b32 s45, 0x12345678, s45
  s_and_b32 s57, s45, 15
  s_or_b32 s45, s2, s36
  s_cmp_lg_u32 s45, 0
  s_cbranch_scc1 L_nonon
  s_memrealtime s[58:59]
  s_waitcnt lgkmcnt(0)
  s_or_b32 s59, s59, 0x80000000
  v_mov_b32 v140, s58
  v_mov_b32 v141, s59
  v_mov_b32 v26, 0
  buffer_store_dwordx2 v[140:141], v26, s[92:95], 0 offen sc1
L_nonon:
  s_barrier
  ds_read_b128 v[80:83], v12 offset:0
  ds_read_b128 v[84:87], v12 offset:2048
  ds_read_b128 v[88:91], v12 offset:4096
  ds_read_b64_tr_b16 v[104:105], v16 offset:12288
  ds_read_b64_tr_b16 v[106:107], v16 offset:13312
  ds_read_b64_tr_b16 v[108:109], v17 offset:12288
  ds_read_b64_tr_b16 v[110:111], v17 offset:13312
  ds_read_b64_tr_b16 v[112:113], v18 offset:12288
  ds_read_b64_tr_b16 v[114:115], v18 offset:13312
  ds_read_b64_tr_b16 v[116:117], v19 offset:12288
  ds_read_b64_tr_b16 v[118:119], v19 offset:13312
  s_waitcnt lgkmcnt(0)
  v_mfma_f32_16x16x32_bf16 v[32:35], v[104:107], v[80:83], 0
  ds_read_b128 v[92:95], v13 offset:0
  ds_read_b128 v[96:99], v13 offset:2048
  v_mfma_f32_16x16x32_bf16 v[36:39], v[104:107], v[84:87], 0
  ds_read_b128 v[100:103], v13 offset:4096
  ds_read_b64_tr_b16 v[120:121], v16 offset:20480
  v_mfma_f32_16x16x32_bf16 v[40:43], v[104:107], v[88:91], 0
  ds_read_b64_tr_b16 v[122:123], v16 offset:21504
  ds_read_b64_tr_b16 v[124:125], v17 offset:20480
  v_mfma_f32_16x16x32_bf16 v[44:47], v[108:111], v[80:83], 0
  ds_read_b64_tr_b16 v[126:127], v17 offset:21504
  ds_read_b64_tr_b16 v[128:129], v18 offset:20480
  v_mfma_f32_16x16x32_bf16 v[48:51], v[108:111], v[84:87], 0
  ds_read_b64_tr_b16 v[130:131], v18 offset:21504
  ds_read_b64_tr_b16 v[132:133], v19 offset:20480
  v_mfma_f32_16x16x32_bf16 v[52:55], v[108:111], v[88:91], 0
  ds_read_b64_tr_b16 v[134:135], v19 offset:21504
  v_mfma_f32_16x16x32_bf16 v[56:59], v[112:115], v[80:83], 0
  v_mfma_f32_16x16x32_bf16 v[60:63], v[112:115], v[84:87], 0
  v_mfma_f32_16x16x32_bf16 v[64:67], v[112:115], v[88:91], 0
  v_mfma_f32_16x16x32_bf16 v[68:71], v[116:119], v[80:83], 0
  v_mfma_f32_16x16x32_bf16 v[72:75], v[116:119], v[84:87], 0
  v_mfma_f32_16x16x32_bf16 v[76:79], v[116:119], v[88:91], 0
  s_waitcnt lgkmcnt(0)
  s_barrier
  v_mfma_f32_16x16x32_bf16 v[32:35], v[120:123], v[92:95], v[32:35]
  ds_read_b128 v[80:83], v12 offset:28672
  ds_read_b128 v[84:87], v12 offset:30720
  v_mfma_f32_16x16x32_bf16 v[36:39], v[120:123], v[96:99], v[36:39]
  ds_read_b128 v[88:91], v12 offset:32768
  ds_read_b64_tr_b16 v[104:105], v16 offset:40960
  v_mfma_f32_16x16x32_bf16 v[40:43], v[120:123], v[100:103], v[40:43]
  ds_read_b64_tr_b16 v[106:107], v16 offset:41984
  ds_read_b64_tr_b16 v[108:109], v17 offset:40960
  v_mfma_f32_16x16x32_bf16 v[44:47], v[124:127], v[92:95], v[44:47]
  ds_read_b64_tr_b16 v[110:111], v17 offset:41984
  ds_read_b64_tr_b16 v[112:113], v18 offset:40960
  v_mfma_f32_16x16x32_bf16 v[48:51], v[124:127], v[96:99], v[48:51]
  ds_read_b64_tr_b16 v[114:115], v18 offset:41984
  ds_read_b64_tr_b16 v[116:117], v19 offset:40960
  v_mfma_f32_16x16x32_bf16 v[52:55], v[124:127], v[100:103], v[52:55]
  ds_read_b64_tr_b16 v[118:119], v19 offset:41984
  v_mfma_f32_16x16x32_bf16 v[56:59], v[128:131], v[92:95], v[56:59]
  v_mfma_f32_16x16x32_bf16 v[60:63], v[128:131], v[96:99], v[60:63]
  v_mfma_f32_16x16x32_bf16 v[64:67], v[128:131], v[100:103], v[64:67]
  v_mfma_f32_16x16x32_bf16 v[68:71], v[132:135], v[92:95], v[68:71]
  v_mfma_f32_16x16x32_bf16 v[72:75], v[132:135], v[96:99], v[72:75]
  v_mfma_f32_16x16x32_bf16 v[76:79], v[132:135], v[100:103], v[76:79]
  s_waitcnt lgkmcnt(0)
  v_mfma_f32_16x16x32_bf16 v[32:35], v[104:107], v[80:83], v[32:35]
  ds_read_b128 v[92:95], v13 offset:28672
  ds_read_b128 v[96:99], v13 offset:30720
  v_mfma_f32_16x16x32_bf16 v[36:39], v[104:107], v[84:87], v[36:39]
  ds_read_b128 v[100:103], v13 offset:32768
  ds_read_b64_tr_b16 v[120:121], v16 offset:49152
  v_mfma_f32_16x16x32_bf16 v[40:43], v[104:107], v[88:91], v[40:43]
  ds_read_b64_tr_b16 v[122:123], v16 offset:50176
  ds_read_b64_tr_b16 v[124:125], v17 offset:49152
  v_mfma_f32_16x16x32_bf16 v[44:47], v[108:111], v[80:83], v[44:47]
  ds_read_b64_tr_b16 v[126:127], v17 offset:50176
  ds_read_b64_tr_b16 v[128:129], v18 offset:49152
  v_mfma_f32_16x16x32_bf16 v[48:51], v[108:111], v[84:87], v[48:51]
  ds_read_b64_tr_b16 v[130:131], v18 offset:50176
  ds_read_b64_tr_b16 v[132:133], v19 offset:49152
  v_mfma_f32_16x16x32_bf16 v[52:55], v[108:111], v[88:91], v[52:55]
  ds_read_b64_tr_b16 v[134:135], v19 offset:50176
  v_mfma_f32_16x16x32_bf16 v[56:59], v[112:115], v[80:83], v[56:59]
  v_mfma_f32_16x16x32_bf16 v[60:63], v[112:115], v[84:87], v[60:63]
  v_mfma_f32_16x16x32_bf16 v[64:67], v[112:115], v[88:91], v[64:67]
  v_mfma_f32_16x16x32_bf16 v[68:71], v[116:119], v[80:83], v[68:71]
  v_mfma_f32_16x16x32_bf16 v[72:75], v[116:119], v[84:87], v[72:75]
  v_mfma_f32_16x16x32_bf16 v[76:79], v[116:119], v[88:91], v[76:79]
  s_waitcnt lgkmcnt(0)
  s_barrier
  v_mfma_f32_16x16x32_bf16 v[32:35], v[120:123], v[92:95], v[32:35]
  ds_read_b128 v[80:83], v14 offset:0
  ds_read_b128 v[84:87], v14 offset:2048
  v_mfma_f32_16x16x32_bf16 v[36:39], v[120:123], v[96:99], v[36:39]
  ds_read_b128 v[88:91], v14 offset:4096
  ds_read_b64_tr_b16 v[104:105], v20 offset:12288
  v_mfma_f32_16x16x32_bf16 v[40:43], v[120:123], v[100:103], v[40:43]
  ds_read_b64_tr_b16 v[106:107], v20 offset:13312
  ds_read_b64_tr_b16 v[108:109], v21 offset:12288
  v_mfma_f32_16x16x32_bf16 v[44:47], v[124:127], v[92:95], v[44:47]
  ds_read_b64_tr_b16 v[110:111], v21 offset:13312
  ds_read_b64_tr_b16 v[112:113], v22 offset:12288
  v_mfma_f32_16x16x32_bf16 v[48:51], v[124:127], v[96:99], v[48:51]
  ds_read_b64_tr_b16 v[114:115], v22 offset:13312
  ds_read_b64_tr_b16 v[116:117], v23 offset:12288
  v_mfma_f32_16x16x32_bf16 v[52:55], v[124:127], v[100:103], v[52:55]
  ds_read_b64_tr_b16 v[118:119], v23 offset:13312
  s_cmp_lg_u32 s57, 1
  s_cbranch_scc1 L_kvs1
  s_add_u32 m0, s48, 0
  s_mov_b32 s49, 0
  buffer_load_dwordx4 v8, s[28:31], s49 offen nt lds
  buffer_load_dwordx4 v9, s[28:31], s49 offen offset:1024 nt lds
  s_add_u32 m0, s48, 0
  s_mov_b32 s49, 0
  buffer_load_dwordx4 v10, s[28:31], s49 offen offset:2048 nt lds
  buffer_load_dwordx4 v11, s[28:31], s49 offen offset:3072 nt lds
  s_add_u32 m0, s48, 4096
  s_mov_b32 s49, 4096
  buffer_load_dwordx4 v8, s[28:31], s49 offen nt lds
  buffer_load_dwordx4 v9, s[28:31], s49 offen offset:1024 nt lds
  s_add_u32 m0, s48, 4096
  s_mov_b32 s49, 4096
  buffer_load_dwordx4 v10, s[28:31], s49 offen offset:2048 nt lds
  buffer_load_dwordx4 v11, s[28:31], s49 offen offset:3072 nt lds
  s_add_u32 m0, s48, 8192
  s_mov_b32 s49, 8192
  buffer_load_dwordx4 v8, s[28:31], s49 offen nt lds
  buffer_load_dwordx4 v9, s[28:31], s49 offen offset:1024 nt lds
  s_add_u32 m0, s48, 8192
  s_mov_b32 s49, 8192
  buffer_load_dwordx4 v10, s[28:31], s49 offen offset:2048 nt lds
  buffer_load_dwordx4 v11, s[28:31], s49 offen offset:3072 nt lds
L_kvs1:
  v_mfma_f32_16x16x32_bf16 v[56:59], v[128:131], v[92:95], v[56:59]
  v_mfma_f32_16x16x32_bf16 v[60:63], v[128:131], v[96:99], v[60:63]
  v_mfma_f32_16x16x32_bf16 v[64:67], v[128:131], v[100:103], v[64:67]
  v_mfma_f32_16x16x32_bf16 v[68:71], v[132:135], v[92:95], v[68:71]
  v_mfma_f32_16x16x32_bf16 v[72:75], v[132:135], v[96:99], v[72:75]
  v_mfma_f32_16x16x32_bf16 v[76:79], v[132:135], v[100:103], v[76:79]
  s_waitcnt lgkmcnt(0)
  v_mfma_f32_16x16x32_bf16 v[32:35], v[104:107], v[80:83], v[32:35]
  ds_read_b128 v[92:95], v15 offset:0
  ds_read_b128 v[96:99], v15 offset:2048
  v_mfma_f32_16x16x32_bf16 v[36:39], v[104:107], v[84:87], v[36:39]
  ds_read_b128 v[100:103], v15 offset:4096
  ds_read_b64_tr_b16 v[120:121], v20 offset:20480
  v_mfma_f32_16x16x32_bf16 v[40:43], v[104:107], v[88:91], v[40:43]
  ds_read_b64_tr_b16 v[122:123], v20 offset:21504
  ds_read_b64_tr_b16 v[124:125], v21 offset:20480
  v_mfma_f32_16x16x32_bf16 v[44:47], v[108:111], v[80:83], v[44:47]
  ds_read_b64_tr_b16 v[126:127], v21 offset:21504
  ds_read_b64_tr_b16 v[128:129], v22 offset:20480
  v_mfma_f32_16x16x32_bf16 v[48:51], v[108:111], v[84:87], v[48:51]
  ds_read_b64_tr_b16 v[130:131], v22 offset:21504
  ds_read_b64_tr_b16 v[132:133], v23 offset:20480
  v_mfma_f32_16x16x32_bf16 v[52:55], v[108:111], v[88:91], v[52:55]
  ds_read_b64_tr_b16 v[134:135], v23 offset:21504
  v_mfma_f32_16x16x32_bf16 v[56:59], v[112:115], v[80:83], v[56:59]
  v_mfma_f32_16x16x32_bf16 v[60:63], v[112:115], v[84:87], v[60:63]
  v_mfma_f32_16x16x32_bf16 v[64:67], v[112:115], v[88:91], v[64:67]
  v_mfma_f32_16x16x32_bf16 v[68:71], v[116:119], v[80:83], v[68:71]
  v_mfma_f32_16x16x32_bf16 v[72:75], v[116:119], v[84:87], v[72:75]
  v_mfma_f32_16x16x32_bf16 v[76:79], v[116:119], v[88:91], v[76:79]
  s_waitcnt lgkmcnt(0)
  s_barrier
  v_mfma_f32_16x16x32_bf16 v[32:35], v[120:123], v[92:95], v[32:35]
  ds_read_b128 v[80:83], v14 offset:28672
  ds_read_b128 v[84:87], v14 offset:30720
  v_mfma_f32_16x16x32_bf16 v[36:39], v[120:123], v[96:99], v[36:39]
  ds_read_b128 v[88:91], v14 offset:32768
  ds_read_b64_tr_b16 v[104:105], v20 offset:40960
  v_mfma_f32_16x16x32_bf16 v[40:43], v[120:123], v[100:103], v[40:43]
  ds_read_b64_tr_b16 v[106:107], v20 offset:41984
  ds_read_b64_tr_b16 v[108:109], v21 offset:40960
  v_mfma_f32_16x16x32_bf16 v[44:47], v[124:127], v[92:95], v[44:47]
  ds_read_b64_tr_b16 v[110:111], v21 offset:41984
  ds_read_b64_tr_b16 v[112:113], v22 offset:40960
  v_mfma_f32_16x16x32_bf16 v[48:51], v[124:127], v[96:99], v[48:51]
  ds_read_b64_tr_b16 v[114:115], v22 offset:41984
  ds_read_b64_tr_b16 v[116:117], v23 offset:40960
  v_mfma_f32_16x16x32_bf16 v[52:55], v[124:127], v[100:103], v[52:55]
  ds_read_b64_tr_b16 v[118:119], v23 offset:41984
  s_cmp_lg_u32 s57, 2
  s_cbranch_scc1 L_kvs2
  s_add_u32 m0, s48, 0
  s_mov_b32 s49, 0
  buffer_load_dwordx4 v8, s[28:31], s49 offen nt lds
  buffer_load_dwordx4 v9, s[28:31], s49 offen offset:1024 nt lds
  s_add_u32 m0, s48, 0
  s_mov_b32 s49, 0
  buffer_load_dwordx4 v10, s[28:31], s49 offen offset:2048 nt lds
  buffer_load_dwordx4 v11, s[28:31], s49 offen offset:3072 nt lds
  s_add_u32 m0, s48, 4096
  s_mov_b32 s49, 4096
  buffer_load_dwordx4 v8, s[28:31], s49 offen nt lds
  buffer_load_dwordx4 v9, s[28:31], s49 offen offset:1024 nt lds
  s_add_u32 m0, s48, 4096
  s_mov_b32 s49, 4096
  buffer_load_dwordx4 v10, s[28:31], s49 offen offset:2048 nt lds
  buffer_load_dwordx4 v11, s[28:31], s49 offen offset:3072 nt lds
  s_add_u32 m0, s48, 8192
  s_mov_b32 s49, 8192
  buffer_load_dwordx4 v8, s[28:31], s49 offen nt lds
  buffer_load_dwordx4 v9, s[28:31], s49 offen offset:1024 nt lds
  s_add_u32 m0, s48, 8192
  s_mov_b32 s49, 8192
  buffer_load_dwordx4 v10, s[28:31], s49 offen offset:2048 nt lds
  buffer_load_dwordx4 v11, s[28:31], s49 offen offset:3072 nt lds
L_kvs2:
  v_mfma_f32_16x16x32_bf16 v[56:59], v[128:131], v[92:95], v[56:59]
  v_mfma_f32_16x16x32_bf16 v[60:63], v[128:131], v[96:99], v[60:63]
  v_mfma_f32_16x16x32_bf16 v[64:67], v[128:131], v[100:103], v[64:67]
  v_mfma_f32_16x16x32_bf16 v[68:71], v[132:135], v[92:95], v[68:71]
  v_mfma_f32_16x16x32_bf16 v[72:75], v[132:135], v[96:99], v[72:75]
  v_mfma_f32_16x16x32_bf16 v[76:79], v[132:135], v[100:103], v[76:79]
  s_waitcnt lgkmcnt(0)
  v_mfma_f32_16x16x32_bf16 v[32:35], v[104:107], v[80:83], v[32:35]
  ds_read_b128 v[92:95], v15 offset:28672
  ds_read_b128 v[96:99], v15 offset:30720
  v_mfma_f32_16x16x32_bf16 v[36:39], v[104:107], v[84:87], v[36:39]
  ds_read_b128 v[100:103], v15 offset:32768
  ds_read_b64_tr_b16 v[120:121], v20 offset:49152
  v_mfma_f32_16x16x32_bf16 v[40:43], v[104:107], v[88:91], v[40:43]
  ds_read_b64_tr_b16 v[122:123], v20 offset:50176
  ds_read_b64_tr_b16 v[124:125], v21 offset:49152
  v_mfma_f32_16x16x32_bf16 v[44:47], v[108:111], v[80:83], v[44:47]
  ds_read_b64_tr_b16 v[126:127], v21 offset:50176
  ds_read_b64_tr_b16 v[128:129], v22 offset:49152
  v_mfma_f32_16x16x32_bf16 v[48:51], v[108:111], v[84:87], v[48:51]
  ds_read_b64_tr_b16 v[130:131], v22 offset:50176
  ds_read_b64_tr_b16 v[132:133], v23 offset:49152
  v_mfma_f32_16x16x32_bf16 v[52:55], v[108:111], v[88:91], v[52:55]
  ds_read_b64_tr_b16 v[134:135], v23 offset:50176
  v_mfma_f32_16x16x32_bf16 v[56:59], v[112:115], v[80:83], v[56:59]
  v_mfma_f32_16x16x32_bf16 v[60:63], v[112:115], v[84:87], v[60:63]
  v_mfma_f32_16x16x32_bf16 v[64:67], v[112:115], v[88:91], v[64:67]
  v_mfma_f32_16x16x32_bf16 v[68:71], v[116:119], v[80:83], v[68:71]
  v_mfma_f32_16x16x32_bf16 v[72:75], v[116:119], v[84:87], v[72:75]
  v_mfma_f32_16x16x32_bf16 v[76:79], v[116:119], v[88:91], v[76:79]
  s_waitcnt lgkmcnt(0)
  s_barrier
  v_mfma_f32_16x16x32_bf16 v[32:35], v[120:123], v[92:95], v[32:35]
  ds_read_b128 v[80:83], v12 offset:0
  ds_read_b128 v[84:87], v12 offset:2048
  v_mfma_f32_16x16x32_bf16 v[36:39], v[120:123], v[96:99], v[36:39]
  ds_read_b128 v[88:91], v12 offset:4096
  ds_read_b64_tr_b16 v[104:105], v16 offset:12288
  v_mfma_f32_16x16x32_bf16 v[40:43], v[120:123], v[100:103], v[40:43]
  ds_read_b64_tr_b16 v[106:107], v16 offset:13312
  ds_read_b64_tr_b16 v[108:109], v17 offset:12288
  v_mfma_f32_16x16x32_bf16 v[44:47], v[124:127], v[92:95], v[44:47]
  ds_read_b64_tr_b16 v[110:111], v17 offset:13312
  ds_read_b64_tr_b16 v[112:113], v18 offset:12288
  v_mfma_f32_16x16x32_bf16 v[48:51], v[124:127], v[96:99], v[48:51]
  ds_read_b64_tr_b16 v[114:115], v18 offset:13312
  ds_read_b64_tr_b16 v[116:117], v19 offset:12288
  v_mfma_f32_16x16x32_bf16 v[52:55], v[124:127], v[100:103], v[52:55]
  ds_read_b64_tr_b16 v[118:119], v19 offset:13312
  s_cmp_lg_u32 s57, 3
  s_cbranch_scc1 L_kvs3
  s_add_u32 m0, s48, 0
  s_mov_b32 s49, 0
  buffer_load_dwordx4 v8, s[28:31], s49 offen nt lds
  buffer_load_dwordx4 v9, s[28:31], s49 offen offset:1024 nt lds
  s_add_u32 m0, s48, 0
  s_mov_b32 s49, 0
  buffer_load_dwordx4 v10, s[28:31], s49 offen offset:2048 nt lds
  buffer_load_dwordx4 v11, s[28:31], s49 offen offset:3072 nt lds
  s_add_u32 m0, s48, 4096
  s_mov_b32 s49, 4096
  buffer_load_dwordx4 v8, s[28:31], s49 offen nt lds
  buffer_load_dwordx4 v9, s[28:31], s49 offen offset:1024 nt lds
  s_add_u32 m0, s48, 4096
  s_mov_b32 s49, 4096
  buffer_load_dwordx4 v10, s[28:31], s49 offen offset:2048 nt lds
  buffer_load_dwordx4 v11, s[28:31], s49 offen offset:3072 nt lds
  s_add_u32 m0, s48, 8192
  s_mov_b32 s49, 8192
  buffer_load_dwordx4 v8, s[28:31], s49 offen nt lds
  buffer_load_dwordx4 v9, s[28:31], s49 offen offset:1024 nt lds
  s_add_u32 m0, s48, 8192
  s_mov_b32 s49, 8192
  buffer_load_dwordx4 v10, s[28:31], s49 offen offset:2048 nt lds
  buffer_load_dwordx4 v11, s[28:31], s49 offen offset:3072 nt lds
L_kvs3:
  v_mfma_f32_16x16x32_bf16 v[56:59], v[128:131], v[92:95], v[56:59]
  v_mfma_f32_16x16x32_bf16 v[60:63], v[128:131], v[96:99], v[60:63]
  v_mfma_f32_16x16x32_bf16 v[64:67], v[128:131], v[100:103], v[64:67]
  v_mfma_f32_16x16x32_bf16 v[68:71], v[132:135], v[92:95], v[68:71]
  v_mfma_f32_16x16x32_bf16 v[72:75], v[132:135], v[96:99], v[72:75]
  v_mfma_f32_16x16x32_bf16 v[76:79], v[132:135], v[100:103], v[76:79]
  s_waitcnt lgkmcnt(0)
  v_mfma_f32_16x16x32_bf16 v[32:35], v[104:107], v[80:83], v[32:35]
  ds_read_b128 v[92:95], v13 offset:0
  ds_read_b128 v[96:99], v13 offset:2048
  v_mfma_f32_16x16x32_bf16 v[36:39], v[104:107], v[84:87], v[36:39]
  ds_read_b128 v[100:103], v13 offset:4096
  ds_read_b64_tr_b16 v[120:121], v16 offset:20480
  v_mfma_f32_16x16x32_bf16 v[40:43], v[104:107], v[88:91], v[40:43]
  ds_read_b64_tr_b16 v[122:123], v16 offset:21504
  ds_read_b64_tr_b16 v[124:125], v17 offset:20480
  v_mfma_f32_16x16x32_bf16 v[44:47], v[108:111], v[80:83], v[44:47]
  ds_read_b64_tr_b16 v[126:127], v17 offset:21504
  ds_read_b64_tr_b16 v[128:129], v18 offset:20480
  v_mfma_f32_16x16x32_bf16 v[48:51], v[108:111], v[84:87], v[48:51]
  ds_read_b64_tr_b16 v[130:131], v18 offset:21504
  ds_read_b64_tr_b16 v[132:133], v19 offset:20480
  v_mfma_f32_16x16x32_bf16 v[52:55], v[108:111], v[88:91], v[52:55]
  ds_read_b64_tr_b16 v[134:135], v19 offset:21504
  v_mfma_f32_16x16x32_bf16 v[56:59], v[112:115], v[80:83], v[56:59]
  v_mfma_f32_16x16x32_bf16 v[60:63], v[112:115], v[84:87], v[60:63]
  v_mfma_f32_16x16x32_bf16 v[64:67], v[112:115], v[88:91], v[64:67]
  v_mfma_f32_16x16x32_bf16 v[68:71], v[116:119], v[80:83], v[68:71]
  v_mfma_f32_16x16x32_bf16 v[72:75], v[116:119], v[84:87], v[72:75]
  v_mfma_f32_16x16x32_bf16 v[76:79], v[116:119], v[88:91], v[76:79]
  s_waitcnt lgkmcnt(0)
  s_barrier
  v_mfma_f32_16x16x32_bf16 v[32:35], v[120:123], v[92:95], v[32:35]
  ds_read_b128 v[80:83], v12 offset:28672
  ds_read_b128 v[84:87], v12 offset:30720
  v_mfma_f32_16x16x32_bf16 v[36:39], v[120:123], v[96:99], v[36:39]
  ds_read_b128 v[88:91], v12 offset:32768
  ds_read_b64_tr_b16 v[104:105], v16 offset:40960
  v_mfma_f32_16x16x32_bf16 v[40:43], v[120:123], v[100:103], v[40:43]
  ds_read_b64_tr_b16 v[106:107], v16 offset:41984
  ds_read_b64_tr_b16 v[108:109], v17 offset:40960
  v_mfma_f32_16x16x32_bf16 v[44:47], v[124:127], v[92:95], v[44:47]
  ds_read_b64_tr_b16 v[110:111], v17 offset:41984
  ds_read_b64_tr_b16 v[112:113], v18 offset:40960
  v_mfma_f32_16x16x32_bf16 v[48:51], v[124:127], v[96:99], v[48:51]
  ds_read_b64_tr_b16 v[114:115], v18 offset:41984
  ds_read_b64_tr_b16 v[116:117], v19 offset:40960
  v_mfma_f32_16x16x32_bf16 v[52:55], v[124:127], v[100:103], v[52:55]
  ds_read_b64_tr_b16 v[118:119], v19 offset:41984
  s_cmp_lg_u32 s57, 4
  s_cbranch_scc1 L_kvs4
  s_add_u32 m0, s48, 0
  s_mov_b32 s49, 0
  buffer_load_dwordx4 v8, s[28:31], s49 offen nt lds
  buffer_load_dwordx4 v9, s[28:31], s49 offen offset:1024 nt lds
  s_add_u32 m0, s48, 0
  s_mov_b32 s49, 0
  buffer_load_dwordx4 v10, s[28:31], s49 offen offset:2048 nt lds
  buffer_load_dwordx4 v11, s[28:31], s49 offen offset:3072 nt lds
  s_add_u32 m0, s48, 4096
  s_mov_b32 s49, 4096
  buffer_load_dwordx4 v8, s[28:31], s49 offen nt lds
  buffer_load_dwordx4 v9, s[28:31], s49 offen offset:1024 nt lds
  s_add_u32 m0, s48, 4096
  s_mov_b32 s49, 4096
  buffer_load_dwordx4 v10, s[28:31], s49 offen offset:2048 nt lds
  buffer_load_dwordx4 v11, s[28:31], s49 offen offset:3072 nt lds
  s_add_u32 m0, s48, 8192
  s_mov_b32 s49, 8192
  buffer_load_dwordx4 v8, s[28:31], s49 offen nt lds
  buffer_load_dwordx4 v9, s[28:31], s49 offen offset:1024 nt lds
  s_add_u32 m0, s48, 8192
  s_mov_b32 s49, 8192
  buffer_load_dwordx4 v10, s[28:31], s49 offen offset:2048 nt lds
  buffer_load_dwordx4 v11, s[28:31], s49 offen offset:3072 nt lds
L_kvs4:
  v_mfma_f32_16x16x32_bf16 v[56:59], v[128:131], v[92:95], v[56:59]
  v_mfma_f32_16x16x32_bf16 v[60:63], v[128:131], v[96:99], v[60:63]
  v_mfma_f32_16x16x32_bf16 v[64:67], v[128:131], v[100:103], v[64:67]
  v_mfma_f32_16x16x32_bf16 v[68:71], v[132:135], v[92:95], v[68:71]
  v_mfma_f32_16x16x32_bf16 v[72:75], v[132:135], v[96:99], v[72:75]
  v_mfma_f32_16x16x32_bf16 v[76:79], v[132:135], v[100:103], v[76:79]
  s_waitcnt lgkmcnt(0)
  v_mfma_f32_16x16x32_bf16 v[32:35], v[104:107], v[80:83], v[32:35]
  ds_read_b128 v[92:95], v13 offset:28672
  ds_read_b128 v[96:99], v13 offset:30720
  v_mfma_f32_16x16x32_bf16 v[36:39], v[104:107], v[84:87], v[36:39]
  ds_read_b128 v[100:103], v13 offset:32768
  ds_read_b64_tr_b16 v[120:121], v16 offset:49152
  v_mfma_f32_16x16x32_bf16 v[40:43], v[104:107], v[88:91], v[40:43]
  ds_read_b64_tr_b16 v[122:123], v16 offset:50176
  ds_read_b64_tr_b16 v[124:125], v17 offset:49152
  v_mfma_f32_16x16x32_bf16 v[44:47], v[108:111], v[80:83], v[44:47]
  ds_read_b64_tr_b16 v[126:127], v17 offset:50176
  ds_read_b64_tr_b16 v[128:129], v18 offset:49152
  v_mfma_f32_16x16x32_bf16 v[48:51], v[108:111], v[84:87], v[48:51]
  ds_read_b64_tr_b16 v[130:131], v18 offset:50176
  ds_read_b64_tr_b16 v[132:133], v19 offset:49152
  v_mfma_f32_16x16x32_bf16 v[52:55], v[108:111], v[88:91], v[52:55]
  ds_read_b64_tr_b16 v[134:135], v19 offset:50176
  v_mfma_f32_16x16x32_bf16 v[56:59], v[112:115], v[80:83], v[56:59]
  v_mfma_f32_16x16x32_bf16 v[60:63], v[112:115], v[84:87], v[60:63]
  v_mfma_f32_16x16x32_bf16 v[64:67], v[112:115], v[88:91], v[64:67]
  v_mfma_f32_16x16x32_bf16 v[68:71], v[116:119], v[80:83], v[68:71]
  v_mfma_f32_16x16x32_bf16 v[72:75], v[116:119], v[84:87], v[72:75]
  v_mfma_f32_16x16x32_bf16 v[76:79], v[116:119], v[88:91], v[76:79]
  s_waitcnt lgkmcnt(0)
  s_barrier
  v_mfma_f32_16x16x32_bf16 v[32:35], v[120:123], v[92:95], v[32:35]
  ds_read_b128 v[80:83], v14 offset:0
  ds_read_b128 v[84:87], v14 offset:2048
  v_mfma_f32_16x16x32_bf16 v[36:39], v[120:123], v[96:99], v[36:39]
  ds_read_b128 v[88:91], v14 offset:4096
  ds_read_b64_tr_b16 v[104:105], v20 offset:12288
  v_mfma_f32_16x16x32_bf16 v[40:43], v[120:123], v[100:103], v[40:43]
  ds_read_b64_tr_b16 v[106:107], v20 offset:13312
  ds_read_b64_tr_b16 v[108:109], v21 offset:12288
  v_mfma_f32_16x16x32_bf16 v[44:47], v[124:127], v[92:95], v[44:47]
  ds_read_b64_tr_b16 v[110:111], v21 offset:13312
  ds_read_b64_tr_b16 v[112:113], v22 offset:12288
  v_mfma_f32_16x16x32_bf16 v[48:51], v[124:127], v[96:99], v[48:51]
  ds_read_b64_tr_b16 v[114:115], v22 offset:13312
  ds_read_b64_tr_b16 v[116:117], v23 offset:12288
  v_mfma_f32_16x16x32_bf16 v[52:55], v[124:127], v[100:103], v[52:55]
  ds_read_b64_tr_b16 v[118:119], v23 offset:13312
  s_cmp_lg_u32 s57, 5
  s_cbranch_scc1 L_kvs5
  s_add_u32 m0, s48, 0
  s_mov_b32 s49, 0
  buffer_load_dwordx4 v8, s[28:31], s49 offen nt lds
  buffer_load_dwordx4 v9, s[28:31], s49 offen offset:1024 nt lds
  s_add_u32 m0, s48, 0
  s_mov_b32 s49, 0
  buffer_load_dwordx4 v10, s[28:31], s49 offen offset:2048 nt lds
  buffer_load_dwordx4 v11, s[28:31], s49 offen offset:3072 nt lds
  s_add_u32 m0, s48, 4096
  s_mov_b32 s49, 4096
  buffer_load_dwordx4 v8, s[28:31], s49 offen nt lds
  buffer_load_dwordx4 v9, s[28:31], s49 offen offset:1024 nt lds
  s_add_u32 m0, s48, 4096
  s_mov_b32 s49, 4096
  buffer_load_dwordx4 v10, s[28:31], s49 offen offset:2048 nt lds
  buffer_load_dwordx4 v11, s[28:31], s49 offen offset:3072 nt lds
  s_add_u32 m0, s48, 8192
  s_mov_b32 s49, 8192
  buffer_load_dwordx4 v8, s[28:31], s49 offen nt lds
  buffer_load_dwordx4 v9, s[28:31], s49 offen offset:1024 nt lds
  s_add_u32 m0, s48, 8192
  s_mov_b32 s49, 8192
  buffer_load_dwordx4 v10, s[28:31], s49 offen offset:2048 nt lds
  buffer_load_dwordx4 v11, s[28:31], s49 offen offset:3072 nt lds
L_kvs5:
  v_mfma_f32_16x16x32_bf16 v[56:59], v[128:131], v[92:95], v[56:59]
  v_mfma_f32_16x16x32_bf16 v[60:63], v[128:131], v[96:99], v[60:63]
  v_mfma_f32_16x16x32_bf16 v[64:67], v[128:131], v[100:103], v[64:67]
  v_mfma_f32_16x16x32_bf16 v[68:71], v[132:135], v[92:95], v[68:71]
  v_mfma_f32_16x16x32_bf16 v[72:75], v[132:135], v[96:99], v[72:75]
  v_mfma_f32_16x16x32_bf16 v[76:79], v[132:135], v[100:103], v[76:79]
  s_waitcnt lgkmcnt(0)
  v_mfma_f32_16x16x32_bf16 v[32:35], v[104:107], v[80:83], v[32:35]
  ds_read_b128 v[92:95], v15 offset:0
  ds_read_b128 v[96:99], v15 offset:2048
  v_mfma_f32_16x16x32_bf16 v[36:39], v[104:107], v[84:87], v[36:39]
  ds_read_b128 v[100:103], v15 offset:4096
  ds_read_b64_tr_b16 v[120:121], v20 offset:20480
  v_mfma_f32_16x16x32_bf16 v[40:43], v[104:107], v[88:91], v[40:43]
  ds_read_b64_tr_b16 v[122:123], v20 offset:21504
  ds_read_b64_tr_b16 v[124:125], v21 offset:20480
  v_mfma_f32_16x16x32_bf16 v[44:47], v[108:111], v[80:83], v[44:47]
  ds_read_b64_tr_b16 v[126:127], v21 offset:21504
  ds_read_b64_tr_b16 v[128:129], v22 offset:20480
  v_mfma_f32_16x16x32_bf16 v[48:51], v[108:111], v[84:87], v[48:51]
  ds_read_b64_tr_b16 v[130:131], v22 offset:21504
  ds_read_b64_tr_b16 v[132:133], v23 offset:20480
  v_mfma_f32_16x16x32_bf16 v[52:55], v[108:111], v[88:91], v[52:55]
  ds_read_b64_tr_b16 v[134:135], v23 offset:21504
  v_mfma_f32_16x16x32_bf16 v[56:59], v[112:115], v[80:83], v[56:59]
  v_mfma_f32_16x16x32_bf16 v[60:63], v[112:115], v[84:87], v[60:63]
  v_mfma_f32_16x16x32_bf16 v[64:67], v[112:115], v[88:91], v[64:67]
  v_mfma_f32_16x16x32_bf16 v[68:71], v[116:119], v[80:83], v[68:71]
  v_mfma_f32_16x16x32_bf16 v[72:75], v[116:119], v[84:87], v[72:75]
  v_mfma_f32_16x16x32_bf16 v[76:79], v[116:119], v[88:91], v[76:79]
  s_waitcnt lgkmcnt(0)
  s_barrier
  v_mfma_f32_16x16x32_bf16 v[32:35], v[120:123], v[92:95], v[32:35]
  ds_read_b128 v[80:83], v14 offset:28672
  ds_read_b128 v[84:87], v14 offset:30720
  v_mfma_f32_16x16x32_bf16 v[36:39], v[120:123], v[96:99], v[36:39]
  ds_read_b128 v[88:91], v14 offset:32768
  ds_read_b64_tr_b16 v[104:105], v20 offset:40960
  v_mfma_f32_16x16x32_bf16 v[40:43], v[120:123], v[100:103], v[40:43]
  ds_read_b64_tr_b16 v[106:107], v20 offset:41984
  ds_read_b64_tr_b16 v[108:109], v21 offset:40960
  v_mfma_f32_16x16x32_bf16 v[44:47], v[124:127], v[92:95], v[44:47]
  ds_read_b64_tr_b16 v[110:111], v21 offset:41984
  ds_read_b64_tr_b16 v[112:113], v22 offset:40960
  v_mfma_f32_16x16x32_bf16 v[48:51], v[124:127], v[96:99], v[48:51]
  ds_read_b64_tr_b16 v[114:115], v22 offset:41984
  ds_read_b64_tr_b16 v[116:117], v23 offset:40960
  v_mfma_f32_16x16x32_bf16 v[52:55], v[124:127], v[100:103], v[52:55]
  ds_read_b64_tr_b16 v[118:119], v23 offset:41984
  s_cmp_lg_u32 s57, 6
  s_cbranch_scc1 L_kvs6
  s_add_u32 m0, s48, 0
  s_mov_b32 s49, 0
  buffer_load_dwordx4 v8, s[28:31], s49 offen nt lds
  buffer_load_dwordx4 v9, s[28:31], s49 offen offset:1024 nt lds
  s_add_u32 m0, s48, 0
  s_mov_b32 s49, 0
  buffer_load_dwordx4 v10, s[28:31], s49 offen offset:2048 nt lds
  buffer_load_dwordx4 v11, s[28:31], s49 offen offset:3072 nt lds
  s_add_u32 m0, s48, 4096
  s_mov_b32 s49, 4096
  buffer_load_dwordx4 v8, s[28:31], s49 offen nt lds
  buffer_load_dwordx4 v9, s[28:31], s49 offen offset:1024 nt lds
  s_add_u32 m0, s48, 4096
  s_mov_b32 s49, 4096
  buffer_load_dwordx4 v10, s[28:31], s49 offen offset:2048 nt lds
  buffer_load_dwordx4 v11, s[28:31], s49 offen offset:3072 nt lds
  s_add_u32 m0, s48, 8192
  s_mov_b32 s49, 8192
  buffer_load_dwordx4 v8, s[28:31], s49 offen nt lds
  buffer_load_dwordx4 v9, s[28:31], s49 offen offset:1024 nt lds
  s_add_u32 m0, s48, 8192
  s_mov_b32 s49, 8192
  buffer_load_dwordx4 v10, s[28:31], s49 offen offset:2048 nt lds
  buffer_load_dwordx4 v11, s[28:31], s49 offen offset:3072 nt lds
L_kvs6:
  v_mfma_f32_16x16x32_bf16 v[56:59], v[128:131], v[92:95], v[56:59]
  v_mfma_f32_16x16x32_bf16 v[60:63], v[128:131], v[96:99], v[60:63]
  v_mfma_f32_16x16x32_bf16 v[64:67], v[128:131], v[100:103], v[64:67]
  v_mfma_f32_16x16x32_bf16 v[68:71], v[132:135], v[92:95], v[68:71]
  v_mfma_f32_16x16x32_bf16 v[72:75], v[132:135], v[96:99], v[72:75]
  v_mfma_f32_16x16x32_bf16 v[76:79], v[132:135], v[100:103], v[76:79]
  s_waitcnt lgkmcnt(0)
  v_mfma_f32_16x16x32_bf16 v[32:35], v[104:107], v[80:83], v[32:35]
  ds_read_b128 v[92:95], v15 offset:28672
  ds_read_b128 v[96:99], v15 offset:30720
  v_mfma_f32_16x16x32_bf16 v[36:39], v[104:107], v[84:87], v[36:39]
  ds_read_b128 v[100:103], v15 offset:32768
  ds_read_b64_tr_b16 v[120:121], v20 offset:49152
  v_mfma_f32_16x16x32_bf16 v[40:43], v[104:107], v[88:91], v[40:43]
  ds_read_b64_tr_b16 v[122:123], v20 offset:50176
  ds_read_b64_tr_b16 v[124:125], v21 offset:49152
  v_mfma_f32_16x16x32_bf16 v[44:47], v[108:111], v[80:83], v[44:47]
  ds_read_b64_tr_b16 v[126:127], v21 offset:50176
  ds_read_b64_tr_b16 v[128:129], v22 offset:49152
  v_mfma_f32_16x16x32_bf16 v[48:51], v[108:111], v[84:87], v[48:51]
  ds_read_b64_tr_b16 v[130:131], v22 offset:50176
  ds_read_b64_tr_b16 v[132:133], v23 offset:49152
  v_mfma_f32_16x16x32_bf16 v[52:55], v[108:111], v[88:91], v[52:55]
  ds_read_b64_tr_b16 v[134:135], v23 offset:50176
  v_mfma_f32_16x16x32_bf16 v[56:59], v[112:115], v[80:83], v[56:59]
  v_mfma_f32_16x16x32_bf16 v[60:63], v[112:115], v[84:87], v[60:63]
  v_mfma_f32_16x16x32_bf16 v[64:67], v[112:115], v[88:91], v[64:67]
  v_mfma_f32_16x16x32_bf16 v[68:71], v[116:119], v[80:83], v[68:71]
  v_mfma_f32_16x16x32_bf16 v[72:75], v[116:119], v[84:87], v[72:75]
  v_mfma_f32_16x16x32_bf16 v[76:79], v[116:119], v[88:91], v[76:79]
  s_waitcnt lgkmcnt(0)
  s_barrier
  v_mfma_f32_16x16x32_bf16 v[32:35], v[120:123], v[92:95], v[32:35]
  ds_read_b128 v[80:83], v12 offset:0
  ds_read_b128 v[84:87], v12 offset:2048
  v_mfma_f32_16x16x32_bf16 v[36:39], v[120:123], v[96:99], v[36:39]
  ds_read_b128 v[88:91], v12 offset:4096
  ds_read_b64_tr_b16 v[104:105], v16 offset:12288
  v_mfma_f32_16x16x32_bf16 v[40:43], v[120:123], v[100:103], v[40:43]
  ds_read_b64_tr_b16 v[106:107], v16 offset:13312
  ds_read_b64_tr_b16 v[108:109], v17 offset:12288
  v_mfma_f32_16x16x32_bf16 v[44:47], v[124:127], v[92:95], v[44:47]
  ds_read_b64_tr_b16 v[110:111], v17 offset:13312
  ds_read_b64_tr_b16 v[112:113], v18 offset:12288
  v_mfma_f32_16x16x32_bf16 v[48:51], v[124:127], v[96:99], v[48:51]
  ds_read_b64_tr_b16 v[114:115], v18 offset:13312
  ds_read_b64_tr_b16 v[116:117], v19 offset:12288
  v_mfma_f32_16x16x32_bf16 v[52:55], v[124:127], v[100:103], v[52:55]
  ds_read_b64_tr_b16 v[118:119], v19 offset:13312
  s_cmp_lg_u32 s57, 7
  s_cbranch_scc1 L_kvs7
  s_add_u32 m0, s48, 0
  s_mov_b32 s49, 0
  buffer_load_dwordx4 v8, s[28:31], s49 offen nt lds
  buffer_load_dwordx4 v9, s[28:31], s49 offen offset:1024 nt lds
  s_add_u32 m0, s48, 0
  s_mov_b32 s49, 0
  buffer_load_dwordx4 v10, s[28:31], s49 offen offset:2048 nt lds
  buffer_load_dwordx4 v11, s[28:31], s49 offen offset:3072 nt lds
  s_add_u32 m0, s48, 4096
  s_mov_b32 s49, 4096
  buffer_load_dwordx4 v8, s[28:31], s49 offen nt lds
  buffer_load_dwordx4 v9, s[28:31], s49 offen offset:1024 nt lds
  s_add_u32 m0, s48, 4096
  s_mov_b32 s49, 4096
  buffer_load_dwordx4 v10, s[28:31], s49 offen offset:2048 nt lds
  buffer_load_dwordx4 v11, s[28:31], s49 offen offset:3072 nt lds
  s_add_u32 m0, s48, 8192
  s_mov_b32 s49, 8192
  buffer_load_dwordx4 v8, s[28:31], s49 offen nt lds
  buffer_load_dwordx4 v9, s[28:31], s49 offen offset:1024 nt lds
  s_add_u32 m0, s48, 8192
  s_mov_b32 s49, 8192
  buffer_load_dwordx4 v10, s[28:31], s49 offen offset:2048 nt lds
  buffer_load_dwordx4 v11, s[28:31], s49 offen offset:3072 nt lds
L_kvs7:
  v_mfma_f32_16x16x32_bf16 v[56:59], v[128:131], v[92:95], v[56:59]
  v_mfma_f32_16x16x32_bf16 v[60:63], v[128:131], v[96:99], v[60:63]
  v_mfma_f32_16x16x32_bf16 v[64:67], v[128:131], v[100:103], v[64:67]
  v_mfma_f32_16x16x32_bf16 v[68:71], v[132:135], v[92:95], v[68:71]
  v_mfma_f32_16x16x32_bf16 v[72:75], v[132:135], v[96:99], v[72:75]
  v_mfma_f32_16x16x32_bf16 v[76:79], v[132:135], v[100:103], v[76:79]
  s_waitcnt lgkmcnt(0)
  v_mfma_f32_16x16x32_bf16 v[32:35], v[104:107], v[80:83], v[32:35]
  ds_read_b128 v[92:95], v13 offset:0
  ds_read_b128 v[96:99], v13 offset:2048
  v_mfma_f32_16x16x32_bf16 v[36:39], v[104:107], v[84:87], v[36:39]
  ds_read_b128 v[100:103], v13 offset:4096
  ds_read_b64_tr_b16 v[120:121], v16 offset:20480
  v_mfma_f32_16x16x32_bf16 v[40:43], v[104:107], v[88:91], v[40:43]
  ds_read_b64_tr_b16 v[122:123], v16 offset:21504
  ds_read_b64_tr_b16 v[124:125], v17 offset:20480
  v_mfma_f32_16x16x32_bf16 v[44:47], v[108:111], v[80:83], v[44:47]
  ds_read_b64_tr_b16 v[126:127], v17 offset:21504
  ds_read_b64_tr_b16 v[128:129], v18 offset:20480
  v_mfma_f32_16x16x32_bf16 v[48:51], v[108:111], v[84:87], v[48:51]
  ds_read_b64_tr_b16 v[130:131], v18 offset:21504
  ds_read_b64_tr_b16 v[132:133], v19 offset:20480
  v_mfma_f32_16x16x32_bf16 v[52:55], v[108:111], v[88:91], v[52:55]
  ds_read_b64_tr_b16 v[134:135], v19 offset:21504
  v_mfma_f32_16x16x32_bf16 v[56:59], v[112:115], v[80:83], v[56:59]
  v_mfma_f32_16x16x32_bf16 v[60:63], v[112:115], v[84:87], v[60:63]
  v_mfma_f32_16x16x32_bf16 v[64:67], v[112:115], v[88:91], v[64:67]
  v_mfma_f32_16x16x32_bf16 v[68:71], v[116:119], v[80:83], v[68:71]
  v_mfma_f32_16x16x32_bf16 v[72:75], v[116:119], v[84:87], v[72:75]
  v_mfma_f32_16x16x32_bf16 v[76:79], v[116:119], v[88:91], v[76:79]
  s_waitcnt lgkmcnt(0)
  s_barrier
  v_mfma_f32_16x16x32_bf16 v[32:35], v[120:123], v[92:95], v[32:35]
  ds_read_b128 v[80:83], v12 offset:28672
  ds_read_b128 v[84:87], v12 offset:30720
  v_mfma_f32_16x16x32_bf16 v[36:39], v[120:123], v[96:99], v[36:39]
  ds_read_b128 v[88:91], v12 offset:32768
  ds_read_b64_tr_b16 v[104:105], v16 offset:40960
  v_mfma_f32_16x16x32_bf16 v[40:43], v[120:123], v[100:103], v[40:43]
  ds_read_b64_tr_b16 v[106:107], v16 offset:41984
  ds_read_b64_tr_b16 v[108:109], v17 offset:40960
  v_mfma_f32_16x16x32_bf16 v[44:47], v[124:127], v[92:95], v[44:47]
  ds_read_b64_tr_b16 v[110:111], v17 offset:41984
  ds_read_b64_tr_b16 v[112:113], v18 offset:40960
  v_mfma_f32_16x16x32_bf16 v[48:51], v[124:127], v[96:99], v[48:51]
  ds_read_b64_tr_b16 v[114:115], v18 offset:41984
  ds_read_b64_tr_b16 v[116:117], v19 offset:40960
  v_mfma_f32_16x16x32_bf16 v[52:55], v[124:127], v[100:103], v[52:55]
  ds_read_b64_tr_b16 v[118:119], v19 offset:41984
  s_cmp_lg_u32 s57, 8
  s_cbranch_scc1 L_kvs8
  s_add_u32 m0, s48, 0
  s_mov_b32 s49, 0
  buffer_load_dwordx4 v8, s[28:31], s49 offen nt lds
  buffer_load_dwordx4 v9, s[28:31], s49 offen offset:1024 nt lds
  s_add_u32 m0, s48, 0
  s_mov_b32 s49, 0
  buffer_load_dwordx4 v10, s[28:31], s49 offen offset:2048 nt lds
  buffer_load_dwordx4 v11, s[28:31], s49 offen offset:3072 nt lds
  s_add_u32 m0, s48, 4096
  s_mov_b32 s49, 4096
  buffer_load_dwordx4 v8, s[28:31], s49 offen nt lds
  buffer_load_dwordx4 v9, s[28:31], s49 offen offset:1024 nt lds
  s_add_u32 m0, s48, 4096
  s_mov_b32 s49, 4096
  buffer_load_dwordx4 v10, s[28:31], s49 offen offset:2048 nt lds
  buffer_load_dwordx4 v11, s[28:31], s49 offen offset:3072 nt lds
  s_add_u32 m0, s48, 8192
  s_mov_b32 s49, 8192
  buffer_load_dwordx4 v8, s[28:31], s49 offen nt lds
  buffer_load_dwordx4 v9, s[28:31], s49 offen offset:1024 nt lds
  s_add_u32 m0, s48, 8192
  s_mov_b32 s49, 8192
  buffer_load_dwordx4 v10, s[28:31], s49 offen offset:2048 nt lds
  buffer_load_dwordx4 v11, s[28:31], s49 offen offset:3072 nt lds
L_kvs8:
  v_mfma_f32_16x16x32_bf16 v[56:59], v[128:131], v[92:95], v[56:59]
  v_mfma_f32_16x16x32_bf16 v[60:63], v[128:131], v[96:99], v[60:63]
  v_mfma_f32_16x16x32_bf16 v[64:67], v[128:131], v[100:103], v[64:67]
  v_mfma_f32_16x16x32_bf16 v[68:71], v[132:135], v[92:95], v[68:71]
  v_mfma_f32_16x16x32_bf16 v[72:75], v[132:135], v[96:99], v[72:75]
  v_mfma_f32_16x16x32_bf16 v[76:79], v[132:135], v[100:103], v[76:79]
  s_waitcnt lgkmcnt(0)
  v_mfma_f32_16x16x32_bf16 v[32:35], v[104:107], v[80:83], v[32:35]
  ds_read_b128 v[92:95], v13 offset:28672
  ds_read_b128 v[96:99], v13 offset:30720
  v_mfma_f32_16x16x32_bf16 v[36:39], v[104:107], v[84:87], v[36:39]
  ds_read_b128 v[100:103], v13 offset:32768
  ds_read_b64_tr_b16 v[120:121], v16 offset:49152
  v_mfma_f32_16x16x32_bf16 v[40:43], v[104:107], v[88:91], v[40:43]
  ds_read_b64_tr_b16 v[122:123], v16 offset:50176
  ds_read_b64_tr_b16 v[124:125], v17 offset:49152
  v_mfma_f32_16x16x32_bf16 v[44:47], v[108:111], v[80:83], v[44:47]
  ds_read_b64_tr_b16 v[126:127], v17 offset:50176
  ds_read_b64_tr_b16 v[128:129], v18 offset:49152
  v_mfma_f32_16x16x32_bf16 v[48:51], v[108:111], v[84:87], v[48:51]
  ds_read_b64_tr_b16 v[130:131], v18 offset:50176
  ds_read_b64_tr_b16 v[132:133], v19 offset:49152
  v_mfma_f32_16x16x32_bf16 v[52:55], v[108:111], v[88:91], v[52:55]
  ds_read_b64_tr_b16 v[134:135], v19 offset:50176
  v_mfma_f32_16x16x32_bf16 v[56:59], v[112:115], v[80:83], v[56:59]
  v_mfma_f32_16x16x32_bf16 v[60:63], v[112:115], v[84:87], v[60:63]
  v_mfma_f32_16x16x32_bf16 v[64:67], v[112:115], v[88:91], v[64:67]
  v_mfma_f32_16x16x32_bf16 v[68:71], v[116:119], v[80:83], v[68:71]
  v_mfma_f32_16x16x32_bf16 v[72:75], v[116:119], v[84:87], v[72:75]
  v_mfma_f32_16x16x32_bf16 v[76:79], v[116:119], v[88:91], v[76:79]
  s_waitcnt lgkmcnt(0)
  s_barrier
  v_mfma_f32_16x16x32_bf16 v[32:35], v[120:123], v[92:95], v[32:35]
  ds_read_b128 v[80:83], v14 offset:0
  ds_read_b128 v[84:87], v14 offset:2048
  v_mfma_f32_16x16x32_bf16 v[36:39], v[120:123], v[96:99], v[36:39]
  ds_read_b128 v[88:91], v14 offset:4096
  ds_read_b64_tr_b16 v[104:105], v20 offset:12288
  v_mfma_f32_16x16x32_bf16 v[40:43], v[120:123], v[100:103], v[40:43]
  ds_read_b64_tr_b16 v[106:107], v20 offset:13312
  ds_read_b64_tr_b16 v[108:109], v21 offset:12288
  v_mfma_f32_16x16x32_bf16 v[44:47], v[124:127], v[92:95], v[44:47]
  ds_read_b64_tr_b16 v[110:111], v21 offset:13312
  ds_read_b64_tr_b16 v[112:113], v22 offset:12288
  v_mfma_f32_16x16x32_bf16 v[48:51], v[124:127], v[96:99], v[48:51]
  ds_read_b64_tr_b16 v[114:115], v22 offset:13312
  ds_read_b64_tr_b16 v[116:117], v23 offset:12288
  v_mfma_f32_16x16x32_bf16 v[52:55], v[124:127], v[100:103], v[52:55]
  ds_read_b64_tr_b16 v[118:119], v23 offset:13312
  v_mov_b32 v26, 0
  v_mfma_f32_16x16x32_bf16 v[56:59], v[128:131], v[92:95], v[56:59]
  buffer_load_dwordx2 v[140:141], v26, s[92:95], 0 offen sc1
  v_mfma_f32_16x16x32_bf16 v[60:63], v[128:131], v[96:99], v[60:63]
  v_mfma_f32_16x16x32_bf16 v[64:67], v[128:131], v[100:103], v[64:67]
  v_mfma_f32_16x16x32_bf16 v[68:71], v[132:135], v[92:95], v[68:71]
  v_mfma_f32_16x16x32_bf16 v[72:75], v[132:135], v[96:99], v[72:75]
  v_mfma_f32_16x16x32_bf16 v[76:79], v[132:135], v[100:103], v[76:79]
  s_waitcnt lgkmcnt(0)
  v_mfma_f32_16x16x32_bf16 v[32:35], v[104:107], v[80:83], v[32:35]
  ds_read_b128 v[92:95], v15 offset:0
  ds_read_b128 v[96:99], v15 offset:2048
  v_mfma_f32_16x16x32_bf16 v[36:39], v[104:107], v[84:87], v[36:39]
  ds_read_b128 v[100:103], v15 offset:4096
  ds_read_b64_tr_b16 v[120:121], v20 offset:20480
  v_mfma_f32_16x16x32_bf16 v[40:43], v[104:107], v[88:91], v[40:43]
  ds_read_b64_tr_b16 v[122:123], v20 offset:21504
  ds_read_b64_tr_b16 v[124:125], v21 offset:20480
  v_mfma_f32_16x16x32_bf16 v[44:47], v[108:111], v[80:83], v[44:47]
  ds_read_b64_tr_b16 v[126:127], v21 offset:21504
  ds_read_b64_tr_b16 v[128:129], v22 offset:20480
  v_mfma_f32_16x16x32_bf16 v[48:51], v[108:111], v[84:87], v[48:51]
  ds_read_b64_tr_b16 v[130:131], v22 offset:21504
  ds_read_b64_tr_b16 v[132:133], v23 offset:20480
  v_mfma_f32_16x16x32_bf16 v[52:55], v[108:111], v[88:91], v[52:55]
  ds_read_b64_tr_b16 v[134:135], v23 offset:21504
  v_mfma_f32_16x16x32_bf16 v[56:59], v[112:115], v[80:83], v[56:59]
  v_mfma_f32_16x16x32_bf16 v[60:63], v[112:115], v[84:87], v[60:63]
  v_mfma_f32_16x16x32_bf16 v[64:67], v[112:115], v[88:91], v[64:67]
  v_mfma_f32_16x16x32_bf16 v[68:71], v[116:119], v[80:83], v[68:71]
  v_mfma_f32_16x16x32_bf16 v[72:75], v[116:119], v[84:87], v[72:75]
  v_mfma_f32_16x16x32_bf16 v[76:79], v[116:119], v[88:91], v[76:79]
  s_waitcnt lgkmcnt(0)
  s_barrier
  v_mfma_f32_16x16x32_bf16 v[32:35], v[120:123], v[92:95], v[32:35]
  ds_read_b128 v[80:83], v14 offset:28672
  ds_read_b128 v[84:87], v14 offset:30720
  v_mfma_f32_16x16x32_bf16 v[36:39], v[120:123], v[96:99], v[36:39]
  ds_read_b128 v[88:91], v14 offset:32768
  ds_read_b64_tr_b16 v[104:105], v20 offset:40960
  v_mfma_f32_16x16x32_bf16 v[40:43], v[120:123], v[100:103], v[40:43]
  ds_read_b64_tr_b16 v[106:107], v20 offset:41984
  ds_read_b64_tr_b16 v[108:109], v21 offset:40960
  v_mfma_f32_16x16x32_bf16 v[44:47], v[124:127], v[92:95], v[44:47]
  ds_read_b64_tr_b16 v[110:111], v21 offset:41984
  ds_read_b64_tr_b16 v[112:113], v22 offset:40960
  v_mfma_f32_16x16x32_bf16 v[48:51], v[124:127], v[96:99], v[48:51]
  ds_read_b64_tr_b16 v[114:115], v22 offset:41984
  ds_read_b64_tr_b16 v[116:117], v23 offset:40960
  v_mfma_f32_16x16x32_bf16 v[52:55], v[124:127], v[100:103], v[52:55]
  ds_read_b64_tr_b16 v[118:119], v23 offset:41984
  v_mfma_f32_16x16x32_bf16 v[56:59], v[128:131], v[92:95], v[56:59]
  v_mfma_f32_16x16x32_bf16 v[60:63], v[128:131], v[96:99], v[60:63]
  v_mfma_f32_16x16x32_bf16 v[64:67], v[128:131], v[100:103], v[64:67]
  v_mfma_f32_16x16x32_bf16 v[68:71], v[132:135], v[92:95], v[68:71]
  v_mfma_f32_16x16x32_bf16 v[72:75], v[132:135], v[96:99], v[72:75]
  v_mfma_f32_16x16x32_bf16 v[76:79], v[132:135], v[100:103], v[76:79]
  s_waitcnt lgkmcnt(0)
  v_mfma_f32_16x16x32_bf16 v[32:35], v[104:107], v[80:83], v[32:35]
  ds_read_b128 v[92:95], v15 offset:28672
  ds_read_b128 v[96:99], v15 offset:30720
  v_mfma_f32_16x16x32_bf16 v[36:39], v[104:107], v[84:87], v[36:39]
  ds_read_b128 v[100:103], v15 offset:32768
  ds_read_b64_tr_b16 v[120:121], v20 offset:49152
  v_mfma_f32_16x16x32_bf16 v[40:43], v[104:107], v[88:91], v[40:43]
  ds_read_b64_tr_b16 v[122:123], v20 offset:50176
  ds_read_b64_tr_b16 v[124:125], v21 offset:49152
  v_mfma_f32_16x16x32_bf16 v[44:47], v[108:111], v[80:83], v[44:47]
  ds_read_b64_tr_b16 v[126:127], v21 offset:50176
  ds_read_b64_tr_b16 v[128:129], v22 offset:49152
  v_mfma_f32_16x16x32_bf16 v[48:51], v[108:111], v[84:87], v[48:51]
  ds_read_b64_tr_b16 v[130:131], v22 offset:50176
  ds_read_b64_tr_b16 v[132:133], v23 offset:49152
  v_mfma_f32_16x16x32_bf16 v[52:55], v[108:111], v[88:91], v[52:55]
  ds_read_b64_tr_b16 v[134:135], v23 offset:50176
  v_mfma_f32_16x16x32_bf16 v[56:59], v[112:115], v[80:83], v[56:59]
  v_mfma_f32_16x16x32_bf16 v[60:63], v[112:115], v[84:87], v[60:63]
  v_mfma_f32_16x16x32_bf16 v[64:67], v[112:115], v[88:91], v[64:67]
  v_mfma_f32_16x16x32_bf16 v[68:71], v[116:119], v[80:83], v[68:71]
  v_mfma_f32_16x16x32_bf16 v[72:75], v[116:119], v[84:87], v[72:75]
  v_mfma_f32_16x16x32_bf16 v[76:79], v[116:119], v[88:91], v[76:79]
  s_waitcnt lgkmcnt(0)
  s_barrier
  v_mfma_f32_16x16x32_bf16 v[32:35], v[120:123], v[92:95], v[32:35]
  ds_read_b128 v[80:83], v12 offset:0
  ds_read_b128 v[84:87], v12 offset:2048
  v_mfma_f32_16x16x32_bf16 v[36:39], v[120:123], v[96:99], v[36:39]
  ds_read_b128 v[88:91], v12 offset:4096
  ds_read_b64_tr_b16 v[104:105], v16 offset:12288
  v_mfma_f32_16x16x32_bf16 v[40:43], v[120:123], v[100:103], v[40:43]
  ds_read_b64_tr_b16 v[106:107], v16 offset:13312
  ds_read_b64_tr_b16 v[108:109], v17 offset:12288
  v_mfma_f32_16x16x32_bf16 v[44:47], v[124:127], v[92:95], v[44:47]
  ds_read_b64_tr_b16 v[110:111], v17 offset:13312
  ds_read_b64_tr_b16 v[112:113], v18 offset:12288
  v_mfma_f32_16x16x32_bf16 v[48:51], v[124:127], v[96:99], v[48:51]
  ds_read_b64_tr_b16 v[114:115], v18 offset:13312
  ds_read_b64_tr_b16 v[116:117], v19 offset:12288
  v_mfma_f32_16x16x32_bf16 v[52:55], v[124:127], v[100:103], v[52:55]
  ds_read_b64_tr_b16 v[118:119], v19 offset:13312
  v_mfma_f32_16x16x32_bf16 v[56:59], v[128:131], v[92:95], v[56:59]
  v_mfma_f32_16x16x32_bf16 v[60:63], v[128:131], v[96:99], v[60:63]
  v_mfma_f32_16x16x32_bf16 v[64:67], v[128:131], v[100:103], v[64:67]
  v_mfma_f32_16x16x32_bf16 v[68:71], v[132:135], v[92:95], v[68:71]
  v_mfma_f32_16x16x32_bf16 v[72:75], v[132:135], v[96:99], v[72:75]
  v_mfma_f32_16x16x32_bf16 v[76:79], v[132:135], v[100:103], v[76:79]
  s_waitcnt lgkmcnt(0)
  v_mfma_f32_16x16x32_bf16 v[32:35], v[104:107], v[80:83], v[32:35]
  ds_read_b128 v[92:95], v13 offset:0
  ds_read_b128 v[96:99], v13 offset:2048
  v_mfma_f32_16x16x32_bf16 v[36:39], v[104:107], v[84:87], v[36:39]
  ds_read_b128 v[100:103], v13 offset:4096
  ds_read_b64_tr_b16 v[120:121], v16 offset:20480
  v_mfma_f32_16x16x32_bf16 v[40:43], v[104:107], v[88:91], v[40:43]
  ds_read_b64_tr_b16 v[122:123], v16 offset:21504
  ds_read_b64_tr_b16 v[124:125], v17 offset:20480
  v_mfma_f32_16x16x32_bf16 v[44:47], v[108:111], v[80:83], v[44:47]
  ds_read_b64_tr_b16 v[126:127], v17 offset:21504
  ds_read_b64_tr_b16 v[128:129], v18 offset:20480
  v_mfma_f32_16x16x32_bf16 v[48:51], v[108:111], v[84:87], v[48:51]
  ds_read_b64_tr_b16 v[130:131], v18 offset:21504
  ds_read_b64_tr_b16 v[132:133], v19 offset:20480
  v_mfma_f32_16x16x32_bf16 v[52:55], v[108:111], v[88:91], v[52:55]
  ds_read_b64_tr_b16 v[134:135], v19 offset:21504
  v_mfma_f32_16x16x32_bf16 v[56:59], v[112:115], v[80:83], v[56:59]
  v_mfma_f32_16x16x32_bf16 v[60:63], v[112:115], v[84:87], v[60:63]
  v_mfma_f32_16x16x32_bf16 v[64:67], v[112:115], v[88:91], v[64:67]
  v_mfma_f32_16x16x32_bf16 v[68:71], v[116:119], v[80:83], v[68:71]
  v_mfma_f32_16x16x32_bf16 v[72:75], v[116:119], v[84:87], v[72:75]
  v_mfma_f32_16x16x32_bf16 v[76:79], v[116:119], v[88:91], v[76:79]
  s_waitcnt lgkmcnt(0)
  s_barrier
  v_mfma_f32_16x16x32_bf16 v[32:35], v[120:123], v[92:95], v[32:35]
  ds_read_b128 v[80:83], v12 offset:28672
  ds_read_b128 v[84:87], v12 offset:30720
  v_mfma_f32_16x16x32_bf16 v[36:39], v[120:123], v[96:99], v[36:39]
  ds_read_b128 v[88:91], v12 offset:32768
  ds_read_b64_tr_b16 v[104:105], v16 offset:40960
  v_mfma_f32_16x16x32_bf16 v[40:43], v[120:123], v[100:103], v[40:43]
  ds_read_b64_tr_b16 v[106:107], v16 offset:41984
  ds_read_b64_tr_b16 v[108:109], v17 offset:40960
  v_mfma_f32_16x16x32_bf16 v[44:47], v[124:127], v[92:95], v[44:47]
  ds_read_b64_tr_b16 v[110:111], v17 offset:41984
  ds_read_b64_tr_b16 v[112:113], v18 offset:40960
  v_mfma_f32_16x16x32_bf16 v[48:51], v[124:127], v[96:99], v[48:51]
  ds_read_b64_tr_b16 v[114:115], v18 offset:41984
  ds_read_b64_tr_b16 v[116:117], v19 offset:40960
  v_mfma_f32_16x16x32_bf16 v[52:55], v[124:127], v[100:103], v[52:55]
  ds_read_b64_tr_b16 v[118:119], v19 offset:41984
  v_mfma_f32_16x16x32_bf16 v[56:59], v[128:131], v[92:95], v[56:59]
  v_mfma_f32_16x16x32_bf16 v[60:63], v[128:131], v[96:99], v[60:63]
  v_mfma_f32_16x16x32_bf16 v[64:67], v[128:131], v[100:103], v[64:67]
  v_mfma_f32_16x16x32_bf16 v[68:71], v[132:135], v[92:95], v[68:71]
  v_mfma_f32_16x16x32_bf16 v[72:75], v[132:135], v[96:99], v[72:75]
  v_mfma_f32_16x16x32_bf16 v[76:79], v[132:135], v[100:103], v[76:79]
  s_waitcnt lgkmcnt(0)
  v_mfma_f32_16x16x32_bf16 v[32:35], v[104:107], v[80:83], v[32:35]
  ds_read_b128 v[92:95], v13 offset:28672
  ds_read_b128 v[96:99], v13 offset:30720
  v_mfma_f32_16x16x32_bf16 v[36:39], v[104:107], v[84:87], v[36:39]
  ds_read_b128 v[100:103], v13 offset:32768
  ds_read_b64_tr_b16 v[120:121], v16 offset:49152
  v_mfma_f32_16x16x32_bf16 v[40:43], v[104:107], v[88:91], v[40:43]
  ds_read_b64_tr_b16 v[122:123], v16 offset:50176
  ds_read_b64_tr_b16 v[124:125], v17 offset:49152
  v_mfma_f32_16x16x32_bf16 v[44:47], v[108:111], v[80:83], v[44:47]
  ds_read_b64_tr_b16 v[126:127], v17 offset:50176
  ds_read_b64_tr_b16 v[128:129], v18 offset:49152
  v_mfma_f32_16x16x32_bf16 v[48:51], v[108:111], v[84:87], v[48:51]
  ds_read_b64_tr_b16 v[130:131], v18 offset:50176
  ds_read_b64_tr_b16 v[132:133], v19 offset:49152
  v_mfma_f32_16x16x32_bf16 v[52:55], v[108:111], v[88:91], v[52:55]
  ds_read_b64_tr_b16 v[134:135], v19 offset:50176
  v_mfma_f32_16x16x32_bf16 v[56:59], v[112:115], v[80:83], v[56:59]
  v_mfma_f32_16x16x32_bf16 v[60:63], v[112:115], v[84:87], v[60:63]
  v_mfma_f32_16x16x32_bf16 v[64:67], v[112:115], v[88:91], v[64:67]
  v_mfma_f32_16x16x32_bf16 v[68:71], v[116:119], v[80:83], v[68:71]
  v_mfma_f32_16x16x32_bf16 v[72:75], v[116:119], v[84:87], v[72:75]
  v_mfma_f32_16x16x32_bf16 v[76:79], v[116:119], v[88:91], v[76:79]
  s_waitcnt vmcnt(0)
  s_waitcnt lgkmcnt(0)
  s_barrier
  v_mfma_f32_16x16x32_bf16 v[32:35], v[120:123], v[92:95], v[32:35]
  ds_read_b128 v[80:83], v14 offset:0
  ds_read_b128 v[84:87], v14 offset:2048
  v_mfma_f32_16x16x32_bf16 v[36:39], v[120:123], v[96:99], v[36:39]
  ds_read_b128 v[88:91], v14 offset:4096
  ds_read_b64_tr_b16 v[104:105], v20 offset:12288
  v_mfma_f32_16x16x32_bf16 v[40:43], v[120:123], v[100:103], v[40:43]
  ds_read_b64_tr_b16 v[106:107], v20 offset:13312
  ds_read_b64_tr_b16 v[108:109], v21 offset:12288
  v_mfma_f32_16x16x32_bf16 v[44:47], v[124:127], v[92:95], v[44:47]
  ds_read_b64_tr_b16 v[110:111], v21 offset:13312
  ds_read_b64_tr_b16 v[112:113], v22 offset:12288
  v_mfma_f32_16x16x32_bf16 v[48:51], v[124:127], v[96:99], v[48:51]
  ds_read_b64_tr_b16 v[114:115], v22 offset:13312
  ds_read_b64_tr_b16 v[116:117], v23 offset:12288
  v_mfma_f32_16x16x32_bf16 v[52:55], v[124:127], v[100:103], v[52:55]
  ds_read_b64_tr_b16 v[118:119], v23 offset:13312
  ds_read_b128 v[144:147], v241
  v_mfma_f32_16x16x32_bf16 v[56:59], v[128:131], v[92:95], v[56:59]
  ds_read_b128 v[148:151], v242
  ds_read_b128 v[152:155], v243
  v_mfma_f32_16x16x32_bf16 v[60:63], v[128:131], v[96:99], v[60:63]
  ds_read_b128 v[156:159], v244
  ds_read_b128 v[160:163], v241 offset:4096
  v_mfma_f32_16x16x32_bf16 v[64:67], v[128:131], v[100:103], v[64:67]
  ds_read_b128 v[164:167], v242 offset:4096
  ds_read_b128 v[168:171], v243 offset:4096
  v_mfma_f32_16x16x32_bf16 v[68:71], v[132:135], v[92:95], v[68:71]
  ds_read_b128 v[172:175], v244 offset:4096
  ds_read_b128 v[176:179], v241 offset:8192
  v_mfma_f32_16x16x32_bf16 v[72:75], v[132:135], v[96:99], v[72:75]
  ds_read_b128 v[180:183], v242 offset:8192
  ds_read_b128 v[184:187], v243 offset:8192
  v_mfma_f32_16x16x32_bf16 v[76:79], v[132:135], v[100:103], v[76:79]
  ds_read_b128 v[188:191], v244 offset:8192
  s_mov_b32 s55, 32768
Ln_c:
  v_readfirstlane_b32 s58, v140
  v_readfirstlane_b32 s59, v141
  s_nop 0
  s_cmp_lg_u32 s59, 0
  s_cbranch_scc1 Lnd_c
  s_sub_u32 s55, s55, 1
  s_cmp_eq_u32 s55, 0
  s_cbranch_scc1 Lnd_c
  s_sleep 2
  v_mov_b32 v26, 0
  buffer_load_dwordx2 v[140:141], v26, s[92:95], 0 offen sc1
  s_waitcnt vmcnt(0)
  s_branch Ln_c
Lnd_c:
  v_mov_b32 v254, s58
  s_waitcnt lgkmcnt(12)
  v_mfma_f32_16x16x32_bf16 v[32:35], v[104:107], v[80:83], v[32:35]
  ds_read_b128 v[92:95], v15 offset:0
  ds_read_b128 v[96:99], v15 offset:2048
  v_mfma_f32_16x16x32_bf16 v[36:39], v[104:107], v[84:87], v[36:39]
  ds_read_b128 v[100:103], v15 offset:4096
  ds_read_b64_tr_b16 v[120:121], v20 offset:20480
  v_mfma_f32_16x16x32_bf16 v[40:43], v[104:107], v[88:91], v[40:43]
  ds_read_b64_tr_b16 v[122:123], v20 offset:21504
  ds_read_b64_tr_b16 v[124:125], v21 offset:20480
  v_mfma_f32_16x16x32_bf16 v[44:47], v[108:111], v[80:83], v[44:47]
  ds_read_b64_tr_b16 v[126:127], v21 offset:21504
  ds_read_b64_tr_b16 v[128:129], v22 offset:20480
  v_mfma_f32_16x16x32_bf16 v[48:51], v[108:111], v[84:87], v[48:51]
  ds_read_b64_tr_b16 v[130:131], v22 offset:21504
  ds_read_b64_tr_b16 v[132:133], v23 offset:20480
  v_mfma_f32_16x16x32_bf16 v[52:55], v[108:111], v[88:91], v[52:55]
  ds_read_b64_tr_b16 v[134:135], v23 offset:21504
  v_mfma_f32_16x16x32_bf16 v[56:59], v[112:115], v[80:83], v[56:59]
  v_mfma_f32_16x16x32_bf16 v[60:63], v[112:115], v[84:87], v[60:63]
  v_mfma_f32_16x16x32_bf16 v[64:67], v[112:115], v[88:91], v[64:67]
  v_mfma_f32_16x16x32_bf16 v[68:71], v[116:119], v[80:83], v[68:71]
  v_mfma_f32_16x16x32_bf16 v[72:75], v[116:119], v[84:87], v[72:75]
  v_mfma_f32_16x16x32_bf16 v[76:79], v[116:119], v[88:91], v[76:79]
  s_waitcnt lgkmcnt(0)
  s_barrier
  v_mfma_f32_16x16x32_bf16 v[32:35], v[120:123], v[92:95], v[32:35]
  ds_read_b128 v[80:83], v14 offset:28672
  ds_read_b128 v[84:87], v14 offset:30720
  v_mfma_f32_16x16x32_bf16 v[36:39], v[120:123], v[96:99], v[36:39]
  ds_read_b128 v[88:91], v14 offset:32768
  ds_read_b64_tr_b16 v[104:105], v20 offset:40960
  v_mfma_f32_16x16x32_bf16 v[40:43], v[120:123], v[100:103], v[40:43]
  ds_read_b64_tr_b16 v[106:107], v20 offset:41984
  ds_read_b64_tr_b16 v[108:109], v21 offset:40960
  v_mfma_f32_16x16x32_bf16 v[44:47], v[124:127], v[92:95], v[44:47]
  ds_read_b64_tr_b16 v[110:111], v21 offset:41984
  ds_read_b64_tr_b16 v[112:113], v22 offset:40960
  v_mfma_f32_16x16x32_bf16 v[48:51], v[124:127], v[96:99], v[48:51]
  ds_read_b64_tr_b16 v[114:115], v22 offset:41984
  ds_read_b64_tr_b16 v[116:117], v23 offset:40960
  v_mfma_f32_16x16x32_bf16 v[52:55], v[124:127], v[100:103], v[52:55]
  ds_read_b64_tr_b16 v[118:119], v23 offset:41984
  ds_read_b64_tr_b16 v[192:193], v245
  v_mfma_f32_16x16x32_bf16 v[56:59], v[128:131], v[92:95], v[56:59]
  ds_read_b64_tr_b16 v[194:195], v245 offset:4096
  ds_read_b64_tr_b16 v[224:225], v245 offset:8192
  v_mfma_f32_16x16x32_bf16 v[60:63], v[128:131], v[96:99], v[60:63]
  ds_read_b64_tr_b16 v[196:197], v246
  ds_read_b64_tr_b16 v[198:199], v246 offset:4096
  v_mfma_f32_16x16x32_bf16 v[64:67], v[128:131], v[100:103], v[64:67]
  ds_read_b64_tr_b16 v[226:227], v246 offset:8192
  ds_read_b64_tr_b16 v[200:201], v247
  v_mfma_f32_16x16x32_bf16 v[68:71], v[132:135], v[92:95], v[68:71]
  ds_read_b64_tr_b16 v[202:203], v247 offset:4096
  ds_read_b64_tr_b16 v[228:229], v247 offset:8192
  v_mfma_f32_16x16x32_bf16 v[72:75], v[132:135], v[96:99], v[72:75]
  ds_read_b64_tr_b16 v[204:205], v248
  ds_read_b64_tr_b16 v[206:207], v248 offset:4096
  v_mfma_f32_16x16x32_bf16 v[76:79], v[132:135], v[100:103], v[76:79]
  ds_read_b64_tr_b16 v[230:231], v248 offset:8192
  s_waitcnt lgkmcnt(12)
  v_mfma_f32_16x16x32_bf16 v[32:35], v[104:107], v[80:83], v[32:35]
  ds_read_b128 v[92:95], v15 offset:28672
  ds_read_b128 v[96:99], v15 offset:30720
  v_mfma_f32_16x16x32_bf16 v[36:39], v[104:107], v[84:87], v[36:39]
  ds_read_b128 v[100:103], v15 offset:32768
  ds_read_b64_tr_b16 v[120:121], v20 offset:49152
  v_mfma_f32_16x16x32_bf16 v[40:43], v[104:107], v[88:91], v[40:43]
  ds_read_b64_tr_b16 v[122:123], v20 offset:50176
  ds_read_b64_tr_b16 v[124:125], v21 offset:49152
  v_mfma_f32_16x16x32_bf16 v[44:47], v[108:111], v[80:83], v[44:47]
  ds_read_b64_tr_b16 v[126:127], v21 offset:50176
  ds_read_b64_tr_b16 v[128:129], v22 offset:49152
  v_mfma_f32_16x16x32_bf16 v[48:51], v[108:111], v[84:87], v[48:51]
  ds_read_b64_tr_b16 v[130:131], v22 offset:50176
  ds_read_b64_tr_b16 v[132:133], v23 offset:49152
  v_mfma_f32_16x16x32_bf16 v[52:55], v[108:111], v[88:91], v[52:55]
  ds_read_b64_tr_b16 v[134:135], v23 offset:50176
  v_mfma_f32_16x16x32_bf16 v[56:59], v[112:115], v[80:83], v[56:59]
  v_mfma_f32_16x16x32_bf16 v[60:63], v[112:115], v[84:87], v[60:63]
  v_mfma_f32_16x16x32_bf16 v[64:67], v[112:115], v[88:91], v[64:67]
  v_mfma_f32_16x16x32_bf16 v[68:71], v[116:119], v[80:83], v[68:71]
  v_mfma_f32_16x16x32_bf16 v[72:75], v[116:119], v[84:87], v[72:75]
  v_mfma_f32_16x16x32_bf16 v[76:79], v[116:119], v[88:91], v[76:79]
  s_waitcnt lgkmcnt(0)
  s_barrier
  v_mfma_f32_16x16x32_bf16 v[32:35], v[120:123], v[92:95], v[32:35]
  ds_read_b64_tr_b16 v[208:209], v249
  ds_read_b64_tr_b16 v[210:211], v249 offset:4096
  v_mfma_f32_16x16x32_bf16 v[36:39], v[120:123], v[96:99], v[36:39]
  ds_read_b64_tr_b16 v[232:233], v249 offset:8192
  ds_read_b64_tr_b16 v[212:213], v250
  v_mfma_f32_16x16x32_bf16 v[40:43], v[120:123], v[100:103], v[40:43]
  ds_read_b64_tr_b16 v[214:215], v250 offset:4096
  ds_read_b64_tr_b16 v[234:235], v250 offset:8192
  v_mfma_f32_16x16x32_bf16 v[44:47], v[124:127], v[92:95], v[44:47]
  ds_read_b64_tr_b16 v[216:217], v251
  ds_read_b64_tr_b16 v[218:219], v251 offset:4096
  v_mfma_f32_16x16x32_bf16 v[48:51], v[124:127], v[96:99], v[48:51]
  ds_read_b64_tr_b16 v[236:237], v251 offset:8192
  ds_read_b64_tr_b16 v[220:221], v252
  v_mfma_f32_16x16x32_bf16 v[52:55], v[124:127], v[100:103], v[52:55]
  ds_read_b64_tr_b16 v[222:223], v252 offset:4096
  ds_read_b64_tr_b16 v[238:239], v252 offset:8192
  v_mfma_f32_16x16x32_bf16 v[56:59], v[128:131], v[92:95], v[56:59]
  v_mfma_f32_16x16x32_bf16 v[60:63], v[128:131], v[96:99], v[60:63]
  v_mfma_f32_16x16x32_bf16 v[64:67], v[128:131], v[100:103], v[64:67]
  v_mfma_f32_16x16x32_bf16 v[68:71], v[132:135], v[92:95], v[68:71]
  v_mfma_f32_16x16x32_bf16 v[72:75], v[132:135], v[96:99], v[72:75]
  v_mfma_f32_16x16x32_bf16 v[76:79], v[132:135], v[100:103], v[76:79]
  s_mul_i32 s45, s50, 28672
  s_lshl_b32 s46, s51, 11
  s_add_u32 s45, s45, s46
  s_add_u32 s45, s45, 57344
  v_lshrrev_b32 v1, 1, v24
  v_lshlrev_b32 v1, 8, v1
  v_and_b32 v2, 1, v24
  v_lshl_add_u32 v1, v2, 3, v1
  v_lshl_add_u32 v1, v25, 4, v1
  v_add_u32 v1, s45, v1
  v_cvt_pk_bf16_f32 v80, v32, v33
  v_cvt_pk_bf16_f32 v81, v34, v35
  ds_write_b64 v1, v[80:81] offset:0
  v_cvt_pk_bf16_f32 v82, v36, v37
  v_cvt_pk_bf16_f32 v83, v38, v39
  ds_write_b64 v1, v[82:83] offset:4096
  v_cvt_pk_bf16_f32 v84, v40, v41
  v_cvt_pk_bf16_f32 v85, v42, v43
  ds_write_b64 v1, v[84:85] offset:8192
  v_cvt_pk_bf16_f32 v86, v44, v45
  v_cvt_pk_bf16_f32 v87, v46, v47
  ds_write_b64 v1, v[86:87] offset:512
  v_cvt_pk_bf16_f32 v88, v48, v49
  v_cvt_pk_bf16_f32 v89, v50, v51
  ds_write_b64 v1, v[88:89] offset:4608
  v_cvt_pk_bf16_f32 v90, v52, v53
  v_cvt_pk_bf16_f32 v91, v54, v55
  ds_write_b64 v1, v[90:91] offset:8704
  v_cvt_pk_bf16_f32 v80, v56, v57
  v_cvt_pk_bf16_f32 v81, v58, v59
  ds_write_b64 v1, v[80:81] offset:1024
  v_cvt_pk_bf16_f32 v82, v60, v61
  v_cvt_pk_bf16_f32 v83, v62, v63
  ds_write_b64 v1, v[82:83] offset:5120
  v_cvt_pk_bf16_f32 v84, v64, v65
  v_cvt_pk_bf16_f32 v85, v66, v67
  ds_write_b64 v1, v[84:85] offset:9216
  v_cvt_pk_bf16_f32 v86, v68, v69
  v_cvt_pk_bf16_f32 v87, v70, v71
  ds_write_b64 v1, v[86:87] offset:1536
  v_cvt_pk_bf16_f32 v88, v72, v73
  v_cvt_pk_bf16_f32 v89, v74, v75
  ds_write_b64 v1, v[88:89] offset:5632
  v_cvt_pk_bf16_f32 v90, v76, v77
  v_cvt_pk_bf16_f32 v91, v78, v79
  ds_write_b64 v1, v[90:91] offset:9728
  s_waitcnt lgkmcnt(0)
L_bq:
  s_barrier
  s_waitcnt lgkmcnt(0)
  s_cmp_ge_u32 s36, 6
  s_cbranch_scc1 L_pref
  s_mov_b32 s56, 0x3fb8aa3b
  ds_read_b128 v[80:83], v240 offset:0
  ds_read_b128 v[84:87], v240 offset:1024
  ds_read_b128 v[88:91], v240 offset:2048
  ds_read_b128 v[92:95], v240 offset:3072
  s_lshl_b32 s45, s38, 5
  s_add_u32 s45, s45, s37
  s_mul_i32 s45, s45, 24576
  s_lshl_b32 s46, s36, 11
  s_add_u32 s45, s45, s46
  s_add_u32 s47, s45, 12288
  s_lshl_b32 s48, s39, 3
  s_add_u32 s48, s48, s38
  s_lshl_b32 s48, s48, 11
  s_lshl_b32 s49, s40, 8
  s_add_u32 s48, s48, s49
  v_mov_b32 v27, 114688
  v_mov_b32 v28, 1
  s_add_u32 s48, s48, 20971520
  v_lshlrev_b32 v243, 4, v0
  v_add_u32 v241, s46, v243
  v_add_u32 v242, 28672, v241
  v_mov_b32 v31, 0
  v_mov_b32 v140, s58
  v_mov_b32 v141, s59
  s_waitcnt lgkmcnt(0)
  v_mfma_f32_16x16x32_bf16 v[32:35], v[144:147], v[80:83], 0
  v_mfma_f32_16x16x32_bf16 v[36:39], v[160:163], v[80:83], 0
  v_mfma_f32_16x16x32_bf16 v[40:43], v[176:179], v[80:83], 0
  v_mfma_f32_16x16x32_bf16 v[32:35], v[148:151], v[84:87], v[32:35]
  v_mfma_f32_16x16x32_bf16 v[36:39], v[164:167], v[84:87], v[36:39]
  v_mfma_f32_16x16x32_bf16 v[40:43], v[180:183], v[84:87], v[40:43]
  v_mfma_f32_16x16x32_bf16 v[32:35], v[152:155], v[88:91], v[32:35]
  v_mfma_f32_16x16x32_bf16 v[36:39], v[168:171], v[88:91], v[36:39]
  v_mfma_f32_16x16x32_bf16 v[40:43], v[184:187], v[88:91], v[40:43]
  v_mfma_f32_16x16x32_bf16 v[32:35], v[156:159], v[92:95], v[32:35]
  v_mfma_f32_16x16x32_bf16 v[36:39], v[172:175], v[92:95], v[36:39]
  v_mfma_f32_16x16x32_bf16 v[40:43], v[188:191], v[92:95], v[40:43]
  s_nop 5
  v_cvt_pk_bf16_f32 v44, 0, v32
  v_cvt_pk_bf16_f32 v45, 0, v33
  v_cvt_pk_bf16_f32 v46, 0, v34
  v_cvt_pk_bf16_f32 v47, 0, v35
  v_cvt_pk_bf16_f32 v48, 0, v36
  v_cvt_pk_bf16_f32 v49, 0, v37
  v_cvt_pk_bf16_f32 v50, 0, v38
  v_cvt_pk_bf16_f32 v51, 0, v39
  v_cvt_pk_bf16_f32 v52, 0, v40
  v_cvt_pk_bf16_f32 v53, 0, v41
  v_cvt_pk_bf16_f32 v54, 0, v42
  v_cvt_pk_bf16_f32 v55, 0, v43
  v_mul_f32 v44, 0x3db504f3, v44
  v_mul_f32 v45, 0x3db504f3, v45
  v_mul_f32 v46, 0x3db504f3, v46
  v_mul_f32 v47, 0x3db504f3, v47
  v_mul_f32 v48, 0x3db504f3, v48
  v_mul_f32 v49, 0x3db504f3, v49
  v_mul_f32 v50, 0x3db504f3, v50
  v_mul_f32 v51, 0x3db504f3, v51
  v_mul_f32 v52, 0x3db504f3, v52
  v_mul_f32 v53, 0x3db504f3, v53
  v_mul_f32 v54, 0x3db504f3, v54
  v_mul_f32 v55, 0x3db504f3, v55
  v_cvt_pk_bf16_f32 v44, 0, v44
  v_cvt_pk_bf16_f32 v45, 0, v45
  v_cvt_pk_bf16_f32 v46, 0, v46
  v_cvt_pk_bf16_f32 v47, 0, v47
  v_cvt_pk_bf16_f32 v48, 0, v48
  v_cvt_pk_bf16_f32 v49, 0, v49
  v_cvt_pk_bf16_f32 v50, 0, v50
  v_cvt_pk_bf16_f32 v51, 0, v51
  v_cvt_pk_bf16_f32 v52, 0, v52
  v_cvt_pk_bf16_f32 v53, 0, v53
  v_cvt_pk_bf16_f32 v54, 0, v54
  v_cvt_pk_bf16_f32 v55, 0, v55
  v_max3_f32 v62, v44, v45, v46
  v_max3_f32 v62, v62, v47, v48
  v_max3_f32 v62, v62, v49, v50
  v_max3_f32 v62, v62, v51, v52
  v_max3_f32 v62, v62, v53, v54
  v_max_f32 v62, v62, v55
  v_mov_b32 v63, v62
  s_nop 1
  v_permlane32_swap_b32 v62, v63
  v_max_f32 v62, v62, v63
  v_mov_b32 v63, v62
  s_nop 1
  v_permlane16_swap_b32 v62, v63
  v_max_f32 v62, v62, v63
  v_mul_f32 v62, s56, v62
  v_fma_f32 v44, v44, s56, -v62
  v_fma_f32 v45, v45, s56, -v62
  v_fma_f32 v46, v46, s56, -v62
  v_fma_f32 v47, v47, s56, -v62
  v_fma_f32 v48, v48, s56, -v62
  v_fma_f32 v49, v49, s56, -v62
  v_fma_f32 v50, v50, s56, -v62
  v_fma_f32 v51, v51, s56, -v62
  v_fma_f32 v52, v52, s56, -v62
  v_fma_f32 v53, v53, s56, -v62
  v_fma_f32 v54, v54, s56, -v62
  v_fma_f32 v55, v55, s56, -v62
  v_exp_f32 v44, v44
  v_exp_f32 v45, v45
  v_exp_f32 v46, v46
  v_exp_f32 v47, v47
  v_exp_f32 v48, v48
  v_exp_f32 v49, v49
  v_exp_f32 v50, v50
  v_exp_f32 v51, v51
  v_exp_f32 v52, v52
  v_exp_f32 v53, v53
  v_exp_f32 v54, v54
  v_exp_f32 v55, v55
  v_add_f32 v64, v44, v45
  v_add_f32 v64, v64, v46
  v_add_f32 v64, v64, v47
  v_add_f32 v64, v64, v48
  v_add_f32 v64, v64, v49
  v_add_f32 v64, v64, v50
  v_add_f32 v64, v64, v51
  v_add_f32 v64, v64, v52
  v_add_f32 v64, v64, v53
  v_add_f32 v64, v64, v54
  v_add_f32 v64, v64, v55
  v_mov_b32 v63, v64
  s_nop 1
  v_permlane32_swap_b32 v64, v63
  v_add_f32 v64, v64, v63
  v_mov_b32 v63, v64
  s_nop 1
  v_permlane16_swap_b32 v64, v63
  v_add_f32 v64, v64, v63
  v_rcp_f32 v64, v64
  s_nop 0
  v_mul_f32 v44, v44, v64
  v_mul_f32 v45, v45, v64
  v_mul_f32 v46, v46, v64
  v_mul_f32 v47, v47, v64
  v_mul_f32 v48, v48, v64
  v_mul_f32 v49, v49, v64
  v_mul_f32 v50, v50, v64
  v_mul_f32 v51, v51, v64
  v_mul_f32 v52, v52, v64
  v_mul_f32 v53, v53, v64
  v_mul_f32 v54, v54, v64
  v_mul_f32 v55, v55, v64
  v_cvt_pk_bf16_f32 v68, v44, v45
  v_cvt_pk_bf16_f32 v69, v46, v47
  v_cvt_pk_bf16_f32 v70, v48, v49
  v_cvt_pk_bf16_f32 v71, v50, v51
  v_cvt_pk_bf16_f32 v72, v52, v53
  v_cvt_pk_bf16_f32 v73, v54, v55
  v_mfma_f32_16x16x32_bf16 v[144:147], v[192:195], v[68:71], 0
  v_mfma_f32_16x16x32_bf16 v[148:151], v[196:199], v[68:71], 0
  v_mfma_f32_16x16x32_bf16 v[152:155], v[200:203], v[68:71], 0
  v_mfma_f32_16x16x32_bf16 v[156:159], v[204:207], v[68:71], 0
  v_mfma_f32_16x16x32_bf16 v[160:163], v[208:211], v[68:71], 0
  v_mfma_f32_16x16x32_bf16 v[164:167], v[212:215], v[68:71], 0
  v_mfma_f32_16x16x32_bf16 v[168:171], v[216:219], v[68:71], 0
  v_mfma_f32_16x16x32_bf16 v[172:175], v[220:223], v[68:71], 0
  v_mfma_f32_16x16x16_bf16 v[144:147], v[224:225], v[72:73], v[144:147]
  v_mfma_f32_16x16x16_bf16 v[148:151], v[226:227], v[72:73], v[148:151]
  v_mfma_f32_16x16x16_bf16 v[152:155], v[228:229], v[72:73], v[152:155]
  v_mfma_f32_16x16x16_bf16 v[156:159], v[230:231], v[72:73], v[156:159]
  v_mfma_f32_16x16x16_bf16 v[160:163], v[232:233], v[72:73], v[160:163]
  v_mfma_f32_16x16x16_bf16 v[164:167], v[234:235], v[72:73], v[164:167]
  v_mfma_f32_16x16x16_bf16 v[168:171], v[236:237], v[72:73], v[168:171]
  v_mfma_f32_16x16x16_bf16 v[172:175], v[238:239], v[72:73], v[172:175]
  s_nop 0
  v_cvt_pk_bf16_f32 v176, v144, v145
  v_cvt_pk_bf16_f32 v177, v146, v147
  v_cvt_pk_bf16_f32 v178, v148, v149
  v_cvt_pk_bf16_f32 v179, v150, v151
  buffer_store_dwordx4 v[176:179], v243, s[32:35], s45 offen sc1
  ds_write_b128 v241, v[176:179]
  v_cvt_pk_bf16_f32 v180, v152, v153
  v_cvt_pk_bf16_f32 v181, v154, v155
  v_cvt_pk_bf16_f32 v182, v156, v157
  v_cvt_pk_bf16_f32 v183, v158, v159
  buffer_store_dwordx4 v[180:183], v243, s[32:35], s45 offen offset:1024 sc1
  ds_write_b128 v241, v[180:183] offset:1024
  v_cvt_pk_bf16_f32 v184, v160, v161
  v_cvt_pk_bf16_f32 v185, v162, v163
  v_cvt_pk_bf16_f32 v186, v164, v165
  v_cvt_pk_bf16_f32 v187, v166, v167
  buffer_store_dwordx4 v[184:187], v243, s[32:35], s47 offen sc1
  ds_write_b128 v242, v[184:187]
  v_cvt_pk_bf16_f32 v188, v168, v169
  v_cvt_pk_bf16_f32 v189, v170, v171
  v_cvt_pk_bf16_f32 v190, v172, v173
  v_cvt_pk_bf16_f32 v191, v174, v175
  buffer_store_dwordx4 v[188:191], v243, s[32:35], s47 offen offset:1024 sc1
  ds_write_b128 v242, v[188:191] offset:1024
  s_waitcnt vmcnt(0)
  s_mov_b64 exec, 1
  ds_add_rtn_u32 v29, v27, v28
  s_waitcnt lgkmcnt(0)
  v_readfirstlane_b32 s49, v29
  s_nop 0
  s_cmp_eq_u32 s49, 5
  s_cbranch_scc0 L_nofl3
  buffer_store_dwordx2 v[140:141], v31, s[32:35], s48 offen sc1
L_nofl3:
  s_mov_b64 exec, -1
  s_cmp_ge_u32 s36, 4
  s_cbranch_scc1 L_ld45
  s_mul_i32 s45, s50, 6144
  v_lshl_add_u32 v12, v0, 4, s45
  v_add_u32 v13, 1024, v12
  v_add_u32 v14, 57344, v12
  v_add_u32 v15, 57344, v13
  v_lshrrev_b32 v26, 2, v25
  v_and_b32 v27, 3, v0
  v_lshl_add_u32 v28, v24, 3, v26
  v_lshlrev_b32 v28, 8, v28
  v_and_b32 v29, 1, v27
  v_lshl_add_u32 v28, v29, 3, v28
  v_and_b32 v29, 1, v24
  v_lshlrev_b32 v29, 3, v29
  v_lshl_add_u32 v29, v26, 1, v29
  v_lshrrev_b32 v27, 1, v27
  s_lshl_b32 s45, s51, 3
  v_or_b32 v27, s45, v27
  v_or_b32 v26, 0, v27
  v_xor_b32 v26, v26, v29
  v_lshl_add_u32 v16, v26, 4, v28
  v_add_u32 v20, 57344, v16
  v_or_b32 v26, 2, v27
  v_xor_b32 v26, v26, v29
  v_lshl_add_u32 v17, v26, 4, v28
  v_add_u32 v21, 57344, v17
  v_or_b32 v26, 4, v27
  v_xor_b32 v26, v26, v29
  v_lshl_add_u32 v18, v26, 4, v28
  v_add_u32 v22, 57344, v18
  v_or_b32 v26, 6, v27
  v_xor_b32 v26, v26, v29
  v_lshl_add_u32 v19, v26, 4, v28
  v_add_u32 v23, 57344, v19
  s_mov_b32 s45, 114688
  v_add_u32 v136, s45, v16
  v_add_u32 v137, s45, v17
  v_add_u32 v138, s45, v18
  v_add_u32 v139, s45, v19
  s_lshl_b32 s49, s40, 3
  s_add_u32 s49, s49, s38
  s_lshl_b32 s49, s49, 2
  v_lshrrev_b32 v26, 2, v25
  v_and_b32 v27, 3, v25
  v_lshl_add_u32 v27, v27, 4, v24
  v_add_u32 v28, s49, v26
  v_lshlrev_b32 v28, 2, v28
  v_add_u32 v28, s36, v28
  v_mul_u32_u24 v28, 6144, v28
  v_subrev_u32 v29, s39, v26
  v_add_u32 v29, 3, v29
  v_and_b32 v29, 3, v29
  v_add_u32 v30, s49, v26
  v_lshlrev_b32 v30, 2, v30
  v_add_u32 v30, s36, v30
  v_lshlrev_b32 v30, 7, v30
  v_lshl_add_u32 v30, v29, 3, v30
  v_add_u32 v6, 21233664, v30
  v_min_u32 v7, 2, v0
  v_lshlrev_b32 v7, 3, v7
  v_lshl_add_u32 v28, v29, 11, v28
  v_and_b32 v29, 3, v25
  v_lshl_add_u32 v29, v29, 2, v24
  v_lshl_add_u32 v28, v29, 4, v28
  v_add_u32 v2, 8388608, v28
  s_mul_i32 s45, s36, 3072
  s_add_u32 s45, s45, 114752
  v_mul_u32_u24 v27, 48, v27
  v_add_u32 v3, s45, v27
  v_mul_u32_u24 v27, 48, v0
  v_add_u32 v5, s45, v27
  v_lshrrev_b32 v27, 2, v25
  v_lshlrev_b32 v27, 4, v27
  v_lshl_add_u32 v27, v24, 2, v27
  v_and_b32 v29, 3, v0
  v_add_u32 v27, v27, v29
  v_lshlrev_b32 v1, 4, v27
  s_lshl_b32 s45, s39, 2
  s_lshl_b32 s42, 0x000f000f, s45
  s_not_b32 s42, s42
  s_mov_b32 s43, s42
  s_add_u32 s46, s49, s39
  s_lshl_b32 s46, s46, 2
  s_add_u32 s46, s46, s36
  s_lshl_b32 s53, s46, 7
  s_add_u32 s53, s53, 21233664
  s_mul_i32 s46, s46, 6144
  s_add_u32 s44, s46, 8388608
  s_mul_i32 s45, s38, 96
  s_mul_i32 s46, s50, 48
  s_add_u32 s45, s45, s46
  s_lshl_b32 s46, s39, 2
  s_add_u32 s45, s45, s46
  s_lshl_b32 s45, s45, 11
  s_lshl_b32 s46, s40, 8
  s_add_u32 s45, s45, s46
  s_lshl_b32 s46, s51, 7
  s_add_u32 s54, s45, s46
  v_lshlrev_b32 v4, 11, v24
  v_lshl_add_u32 v4, v25, 3, v4
  s_waitcnt lgkmcnt(0)
  s_barrier
  ds_read_b128 v[80:83], v12 offset:0
  ds_read_b128 v[84:87], v12 offset:2048
  ds_read_b128 v[88:91], v12 offset:4096
  ds_read_b64_tr_b16 v[104:105], v16 offset:12288
  ds_read_b64_tr_b16 v[106:107], v16 offset:13312
  ds_read_b64_tr_b16 v[108:109], v17 offset:12288
  ds_read_b64_tr_b16 v[110:111], v17 offset:13312
  ds_read_b64_tr_b16 v[112:113], v18 offset:12288
  ds_read_b64_tr_b16 v[114:115], v18 offset:13312
  ds_read_b64_tr_b16 v[116:117], v19 offset:12288
  ds_read_b64_tr_b16 v[118:119], v19 offset:13312
  s_waitcnt lgkmcnt(0)
  v_mfma_f32_16x16x32_bf16 v[32:35], v[104:107], v[80:83], 0
  ds_read_b128 v[92:95], v13 offset:0
  ds_read_b128 v[96:99], v13 offset:2048
  v_mfma_f32_16x16x32_bf16 v[36:39], v[104:107], v[84:87], 0
  ds_read_b128 v[100:103], v13 offset:4096
  ds_read_b64_tr_b16 v[120:121], v16 offset:20480
  v_mfma_f32_16x16x32_bf16 v[40:43], v[104:107], v[88:91], 0
  ds_read_b64_tr_b16 v[122:123], v16 offset:21504
  ds_read_b64_tr_b16 v[124:125], v17 offset:20480
  v_mfma_f32_16x16x32_bf16 v[44:47], v[108:111], v[80:83], 0
  ds_read_b64_tr_b16 v[126:127], v17 offset:21504
  ds_read_b64_tr_b16 v[128:129], v18 offset:20480
  v_mfma_f32_16x16x32_bf16 v[48:51], v[108:111], v[84:87], 0
  ds_read_b64_tr_b16 v[130:131], v18 offset:21504
  ds_read_b64_tr_b16 v[132:133], v19 offset:20480
  v_mfma_f32_16x16x32_bf16 v[52:55], v[108:111], v[88:91], 0
  ds_read_b64_tr_b16 v[134:135], v19 offset:21504
  v_mfma_f32_16x16x32_bf16 v[56:59], v[112:115], v[80:83], 0
  v_mfma_f32_16x16x32_bf16 v[60:63], v[112:115], v[84:87], 0
  v_mfma_f32_16x16x32_bf16 v[64:67], v[112:115], v[88:91], 0
  v_mfma_f32_16x16x32_bf16 v[68:71], v[116:119], v[80:83], 0
  v_mfma_f32_16x16x32_bf16 v[72:75], v[116:119], v[84:87], 0
  v_mfma_f32_16x16x32_bf16 v[76:79], v[116:119], v[88:91], 0
  s_waitcnt lgkmcnt(0)
  s_barrier
  v_mfma_f32_16x16x32_bf16 v[32:35], v[120:123], v[92:95], v[32:35]
  ds_read_b128 v[80:83], v12 offset:28672
  ds_read_b128 v[84:87], v12 offset:30720
  v_mfma_f32_16x16x32_bf16 v[36:39], v[120:123], v[96:99], v[36:39]
  ds_read_b128 v[88:91], v12 offset:32768
  ds_read_b64_tr_b16 v[104:105], v16 offset:40960
  v_mfma_f32_16x16x32_bf16 v[40:43], v[120:123], v[100:103], v[40:43]
  ds_read_b64_tr_b16 v[106:107], v16 offset:41984
  ds_read_b64_tr_b16 v[108:109], v17 offset:40960
  v_mfma_f32_16x16x32_bf16 v[44:47], v[124:127], v[92:95], v[44:47]
  ds_read_b64_tr_b16 v[110:111], v17 offset:41984
  ds_read_b64_tr_b16 v[112:113], v18 offset:40960
  v_mfma_f32_16x16x32_bf16 v[48:51], v[124:127], v[96:99], v[48:51]
  ds_read_b64_tr_b16 v[114:115], v18 offset:41984
  ds_read_b64_tr_b16 v[116:117], v19 offset:40960
  v_mfma_f32_16x16x32_bf16 v[52:55], v[124:127], v[100:103], v[52:55]
  ds_read_b64_tr_b16 v[118:119], v19 offset:41984
  v_mfma_f32_16x16x32_bf16 v[56:59], v[128:131], v[92:95], v[56:59]
  v_mfma_f32_16x16x32_bf16 v[60:63], v[128:131], v[96:99], v[60:63]
  v_mfma_f32_16x16x32_bf16 v[64:67], v[128:131], v[100:103], v[64:67]
  v_mfma_f32_16x16x32_bf16 v[68:71], v[132:135], v[92:95], v[68:71]
  v_mfma_f32_16x16x32_bf16 v[72:75], v[132:135], v[96:99], v[72:75]
  v_mfma_f32_16x16x32_bf16 v[76:79], v[132:135], v[100:103], v[76:79]
  s_waitcnt lgkmcnt(0)
  v_mfma_f32_16x16x32_bf16 v[32:35], v[104:107], v[80:83], v[32:35]
  ds_read_b128 v[92:95], v13 offset:28672
  ds_read_b128 v[96:99], v13 offset:30720
  v_mfma_f32_16x16x32_bf16 v[36:39], v[104:107], v[84:87], v[36:39]
  ds_read_b128 v[100:103], v13 offset:32768
  ds_read_b64_tr_b16 v[120:121], v16 offset:49152
  v_mfma_f32_16x16x32_bf16 v[40:43], v[104:107], v[88:91], v[40:43]
  ds_read_b64_tr_b16 v[122:123], v16 offset:50176
  ds_read_b64_tr_b16 v[124:125], v17 offset:49152
  v_mfma_f32_16x16x32_bf16 v[44:47], v[108:111], v[80:83], v[44:47]
  ds_read_b64_tr_b16 v[126:127], v17 offset:50176
  ds_read_b64_tr_b16 v[128:129], v18 offset:49152
  v_mfma_f32_16x16x32_bf16 v[48:51], v[108:111], v[84:87], v[48:51]
  ds_read_b64_tr_b16 v[130:131], v18 offset:50176
  ds_read_b64_tr_b16 v[132:133], v19 offset:49152
  v_mfma_f32_16x16x32_bf16 v[52:55], v[108:111], v[88:91], v[52:55]
  ds_read_b64_tr_b16 v[134:135], v19 offset:50176
  v_mfma_f32_16x16x32_bf16 v[56:59], v[112:115], v[80:83], v[56:59]
  v_mfma_f32_16x16x32_bf16 v[60:63], v[112:115], v[84:87], v[60:63]
  v_mfma_f32_16x16x32_bf16 v[64:67], v[112:115], v[88:91], v[64:67]
  v_mfma_f32_16x16x32_bf16 v[68:71], v[116:119], v[80:83], v[68:71]
  v_mfma_f32_16x16x32_bf16 v[72:75], v[116:119], v[84:87], v[72:75]
  v_mfma_f32_16x16x32_bf16 v[76:79], v[116:119], v[88:91], v[76:79]
  s_waitcnt lgkmcnt(0)
  s_barrier
  v_mfma_f32_16x16x32_bf16 v[32:35], v[120:123], v[92:95], v[32:35]
  ds_read_b128 v[80:83], v14 offset:0
  ds_read_b128 v[84:87], v14 offset:2048
  v_mfma_f32_16x16x32_bf16 v[36:39], v[120:123], v[96:99], v[36:39]
  ds_read_b128 v[88:91], v14 offset:4096
  ds_read_b64_tr_b16 v[104:105], v20 offset:12288
  v_mfma_f32_16x16x32_bf16 v[40:43], v[120:123], v[100:103], v[40:43]
  ds_read_b64_tr_b16 v[106:107], v20 offset:13312
  ds_read_b64_tr_b16 v[108:109], v21 offset:12288
  v_mfma_f32_16x16x32_bf16 v[44:47], v[124:127], v[92:95], v[44:47]
  ds_read_b64_tr_b16 v[110:111], v21 offset:13312
  ds_read_b64_tr_b16 v[112:113], v22 offset:12288
  v_mfma_f32_16x16x32_bf16 v[48:51], v[124:127], v[96:99], v[48:51]
  ds_read_b64_tr_b16 v[114:115], v22 offset:13312
  ds_read_b64_tr_b16 v[116:117], v23 offset:12288
  v_mfma_f32_16x16x32_bf16 v[52:55], v[124:127], v[100:103], v[52:55]
  ds_read_b64_tr_b16 v[118:119], v23 offset:13312
  v_mfma_f32_16x16x32_bf16 v[56:59], v[128:131], v[92:95], v[56:59]
  v_mfma_f32_16x16x32_bf16 v[60:63], v[128:131], v[96:99], v[60:63]
  v_mfma_f32_16x16x32_bf16 v[64:67], v[128:131], v[100:103], v[64:67]
  v_mfma_f32_16x16x32_bf16 v[68:71], v[132:135], v[92:95], v[68:71]
  v_mfma_f32_16x16x32_bf16 v[72:75], v[132:135], v[96:99], v[72:75]
  v_mfma_f32_16x16x32_bf16 v[76:79], v[132:135], v[100:103], v[76:79]
  s_waitcnt lgkmcnt(0)
  v_mfma_f32_16x16x32_bf16 v[32:35], v[104:107], v[80:83], v[32:35]
  ds_read_b128 v[92:95], v15 offset:0
  ds_read_b128 v[96:99], v15 offset:2048
  v_mfma_f32_16x16x32_bf16 v[36:39], v[104:107], v[84:87], v[36:39]
  ds_read_b128 v[100:103], v15 offset:4096
  ds_read_b64_tr_b16 v[120:121], v20 offset:20480
  v_mfma_f32_16x16x32_bf16 v[40:43], v[104:107], v[88:91], v[40:43]
  ds_read_b64_tr_b16 v[122:123], v20 offset:21504
  ds_read_b64_tr_b16 v[124:125], v21 offset:20480
  v_mfma_f32_16x16x32_bf16 v[44:47], v[108:111], v[80:83], v[44:47]
  ds_read_b64_tr_b16 v[126:127], v21 offset:21504
  ds_read_b64_tr_b16 v[128:129], v22 offset:20480
  v_mfma_f32_16x16x32_bf16 v[48:51], v[108:111], v[84:87], v[48:51]
  ds_read_b64_tr_b16 v[130:131], v22 offset:21504
  ds_read_b64_tr_b16 v[132:133], v23 offset:20480
  v_mfma_f32_16x16x32_bf16 v[52:55], v[108:111], v[88:91], v[52:55]
  ds_read_b64_tr_b16 v[134:135], v23 offset:21504
  v_mfma_f32_16x16x32_bf16 v[56:59], v[112:115], v[80:83], v[56:59]
  v_mfma_f32_16x16x32_bf16 v[60:63], v[112:115], v[84:87], v[60:63]
  v_mfma_f32_16x16x32_bf16 v[64:67], v[112:115], v[88:91], v[64:67]
  v_mfma_f32_16x16x32_bf16 v[68:71], v[116:119], v[80:83], v[68:71]
  v_mfma_f32_16x16x32_bf16 v[72:75], v[116:119], v[84:87], v[72:75]
  v_mfma_f32_16x16x32_bf16 v[76:79], v[116:119], v[88:91], v[76:79]
  s_waitcnt lgkmcnt(0)
  s_barrier
  v_mfma_f32_16x16x32_bf16 v[32:35], v[120:123], v[92:95], v[32:35]
  ds_read_b128 v[80:83], v14 offset:28672
  ds_read_b128 v[84:87], v14 offset:30720
  v_mfma_f32_16x16x32_bf16 v[36:39], v[120:123], v[96:99], v[36:39]
  ds_read_b128 v[88:91], v14 offset:32768
  ds_read_b64_tr_b16 v[104:105], v20 offset:40960
  v_mfma_f32_16x16x32_bf16 v[40:43], v[120:123], v[100:103], v[40:43]
  ds_read_b64_tr_b16 v[106:107], v20 offset:41984
  ds_read_b64_tr_b16 v[108:109], v21 offset:40960
  v_mfma_f32_16x16x32_bf16 v[44:47], v[124:127], v[92:95], v[44:47]
  ds_read_b64_tr_b16 v[110:111], v21 offset:41984
  ds_read_b64_tr_b16 v[112:113], v22 offset:40960
  v_mfma_f32_16x16x32_bf16 v[48:51], v[124:127], v[96:99], v[48:51]
  ds_read_b64_tr_b16 v[114:115], v22 offset:41984
  ds_read_b64_tr_b16 v[116:117], v23 offset:40960
  v_mfma_f32_16x16x32_bf16 v[52:55], v[124:127], v[100:103], v[52:55]
  ds_read_b64_tr_b16 v[118:119], v23 offset:41984
  v_mfma_f32_16x16x32_bf16 v[56:59], v[128:131], v[92:95], v[56:59]
  v_mfma_f32_16x16x32_bf16 v[60:63], v[128:131], v[96:99], v[60:63]
  v_mfma_f32_16x16x32_bf16 v[64:67], v[128:131], v[100:103], v[64:67]
  v_mfma_f32_16x16x32_bf16 v[68:71], v[132:135], v[92:95], v[68:71]
  v_mfma_f32_16x16x32_bf16 v[72:75], v[132:135], v[96:99], v[72:75]
  v_mfma_f32_16x16x32_bf16 v[76:79], v[132:135], v[100:103], v[76:79]
  s_waitcnt lgkmcnt(0)
  v_mfma_f32_16x16x32_bf16 v[32:35], v[104:107], v[80:83], v[32:35]
  ds_read_b128 v[92:95], v15 offset:28672
  ds_read_b128 v[96:99], v15 offset:30720
  v_mfma_f32_16x16x32_bf16 v[36:39], v[104:107], v[84:87], v[36:39]
  ds_read_b128 v[100:103], v15 offset:32768
  ds_read_b64_tr_b16 v[120:121], v20 offset:49152
  v_mfma_f32_16x16x32_bf16 v[40:43], v[104:107], v[88:91], v[40:43]
  ds_read_b64_tr_b16 v[122:123], v20 offset:50176
  ds_read_b64_tr_b16 v[124:125], v21 offset:49152
  v_mfma_f32_16x16x32_bf16 v[44:47], v[108:111], v[80:83], v[44:47]
  ds_read_b64_tr_b16 v[126:127], v21 offset:50176
  ds_read_b64_tr_b16 v[128:129], v22 offset:49152
  v_mfma_f32_16x16x32_bf16 v[48:51], v[108:111], v[84:87], v[48:51]
  ds_read_b64_tr_b16 v[130:131], v22 offset:50176
  ds_read_b64_tr_b16 v[132:133], v23 offset:49152
  v_mfma_f32_16x16x32_bf16 v[52:55], v[108:111], v[88:91], v[52:55]
  ds_read_b64_tr_b16 v[134:135], v23 offset:50176
  v_mfma_f32_16x16x32_bf16 v[56:59], v[112:115], v[80:83], v[56:59]
  v_mfma_f32_16x16x32_bf16 v[60:63], v[112:115], v[84:87], v[60:63]
  v_mfma_f32_16x16x32_bf16 v[64:67], v[112:115], v[88:91], v[64:67]
  v_mfma_f32_16x16x32_bf16 v[68:71], v[116:119], v[80:83], v[68:71]
  v_mfma_f32_16x16x32_bf16 v[72:75], v[116:119], v[84:87], v[72:75]
  v_mfma_f32_16x16x32_bf16 v[76:79], v[116:119], v[88:91], v[76:79]
  s_waitcnt lgkmcnt(0)
  s_barrier
  v_mfma_f32_16x16x32_bf16 v[32:35], v[120:123], v[92:95], v[32:35]
  ds_read_b128 v[80:83], v12 offset:0
  ds_read_b128 v[84:87], v12 offset:2048
  v_mfma_f32_16x16x32_bf16 v[36:39], v[120:123], v[96:99], v[36:39]
  ds_read_b128 v[88:91], v12 offset:4096
  ds_read_b64_tr_b16 v[104:105], v136 offset:0
  v_mfma_f32_16x16x32_bf16 v[40:43], v[120:123], v[100:103], v[40:43]
  ds_read_b64_tr_b16 v[106:107], v136 offset:1024
  ds_read_b64_tr_b16 v[108:109], v137 offset:0
  v_mfma_f32_16x16x32_bf16 v[44:47], v[124:127], v[92:95], v[44:47]
  ds_read_b64_tr_b16 v[110:111], v137 offset:1024
  ds_read_b64_tr_b16 v[112:113], v138 offset:0
  v_mfma_f32_16x16x32_bf16 v[48:51], v[124:127], v[96:99], v[48:51]
  ds_read_b64_tr_b16 v[114:115], v138 offset:1024
  ds_read_b64_tr_b16 v[116:117], v139 offset:0
  v_mfma_f32_16x16x32_bf16 v[52:55], v[124:127], v[100:103], v[52:55]
  ds_read_b64_tr_b16 v[118:119], v139 offset:1024
  v_mfma_f32_16x16x32_bf16 v[56:59], v[128:131], v[92:95], v[56:59]
  v_mfma_f32_16x16x32_bf16 v[60:63], v[128:131], v[96:99], v[60:63]
  v_mfma_f32_16x16x32_bf16 v[64:67], v[128:131], v[100:103], v[64:67]
  v_mfma_f32_16x16x32_bf16 v[68:71], v[132:135], v[92:95], v[68:71]
  v_mfma_f32_16x16x32_bf16 v[72:75], v[132:135], v[96:99], v[72:75]
  v_mfma_f32_16x16x32_bf16 v[76:79], v[132:135], v[100:103], v[76:79]
  s_waitcnt lgkmcnt(0)
  v_mfma_f32_16x16x32_bf16 v[32:35], v[104:107], v[80:83], v[32:35]
  ds_read_b128 v[92:95], v13 offset:0
  ds_read_b128 v[96:99], v13 offset:2048
  v_mfma_f32_16x16x32_bf16 v[36:39], v[104:107], v[84:87], v[36:39]
  ds_read_b128 v[100:103], v13 offset:4096
  ds_read_b64_tr_b16 v[120:121], v136 offset:8192
  v_mfma_f32_16x16x32_bf16 v[40:43], v[104:107], v[88:91], v[40:43]
  ds_read_b64_tr_b16 v[122:123], v136 offset:9216
  ds_read_b64_tr_b16 v[124:125], v137 offset:8192
  v_mfma_f32_16x16x32_bf16 v[44:47], v[108:111], v[80:83], v[44:47]
  ds_read_b64_tr_b16 v[126:127], v137 offset:9216
  ds_read_b64_tr_b16 v[128:129], v138 offset:8192
  v_mfma_f32_16x16x32_bf16 v[48:51], v[108:111], v[84:87], v[48:51]
  ds_read_b64_tr_b16 v[130:131], v138 offset:9216
  ds_read_b64_tr_b16 v[132:133], v139 offset:8192
  v_mfma_f32_16x16x32_bf16 v[52:55], v[108:111], v[88:91], v[52:55]
  ds_read_b64_tr_b16 v[134:135], v139 offset:9216
  v_mfma_f32_16x16x32_bf16 v[56:59], v[112:115], v[80:83], v[56:59]
  v_mfma_f32_16x16x32_bf16 v[60:63], v[112:115], v[84:87], v[60:63]
  v_mfma_f32_16x16x32_bf16 v[64:67], v[112:115], v[88:91], v[64:67]
  v_mfma_f32_16x16x32_bf16 v[68:71], v[116:119], v[80:83], v[68:71]
  v_mfma_f32_16x16x32_bf16 v[72:75], v[116:119], v[84:87], v[72:75]
  v_mfma_f32_16x16x32_bf16 v[76:79], v[116:119], v[88:91], v[76:79]
  s_waitcnt lgkmcnt(0)
  s_barrier
  v_mfma_f32_16x16x32_bf16 v[32:35], v[120:123], v[92:95], v[32:35]
  ds_read_b128 v[80:83], v12 offset:28672
  ds_read_b128 v[84:87], v12 offset:30720
  v_mfma_f32_16x16x32_bf16 v[36:39], v[120:123], v[96:99], v[36:39]
  ds_read_b128 v[88:91], v12 offset:32768
  ds_read_b64_tr_b16 v[104:105], v136 offset:16384
  v_mfma_f32_16x16x32_bf16 v[40:43], v[120:123], v[100:103], v[40:43]
  ds_read_b64_tr_b16 v[106:107], v136 offset:17408
  ds_read_b64_tr_b16 v[108:109], v137 offset:16384
  v_mfma_f32_16x16x32_bf16 v[44:47], v[124:127], v[92:95], v[44:47]
  ds_read_b64_tr_b16 v[110:111], v137 offset:17408
  ds_read_b64_tr_b16 v[112:113], v138 offset:16384
  v_mfma_f32_16x16x32_bf16 v[48:51], v[124:127], v[96:99], v[48:51]
  ds_read_b64_tr_b16 v[114:115], v138 offset:17408
  ds_read_b64_tr_b16 v[116:117], v139 offset:16384
  v_mfma_f32_16x16x32_bf16 v[52:55], v[124:127], v[100:103], v[52:55]
  ds_read_b64_tr_b16 v[118:119], v139 offset:17408
  v_mfma_f32_16x16x32_bf16 v[56:59], v[128:131], v[92:95], v[56:59]
  v_mfma_f32_16x16x32_bf16 v[60:63], v[128:131], v[96:99], v[60:63]
  v_mfma_f32_16x16x32_bf16 v[64:67], v[128:131], v[100:103], v[64:67]
  v_mfma_f32_16x16x32_bf16 v[68:71], v[132:135], v[92:95], v[68:71]
  v_mfma_f32_16x16x32_bf16 v[72:75], v[132:135], v[96:99], v[72:75]
  v_mfma_f32_16x16x32_bf16 v[76:79], v[132:135], v[100:103], v[76:79]
  s_waitcnt lgkmcnt(0)
  v_mfma_f32_16x16x32_bf16 v[32:35], v[104:107], v[80:83], v[32:35]
  ds_read_b128 v[92:95], v13 offset:28672
  ds_read_b128 v[96:99], v13 offset:30720
  v_mfma_f32_16x16x32_bf16 v[36:39], v[104:107], v[84:87], v[36:39]
  ds_read_b128 v[100:103], v13 offset:32768
  ds_read_b64_tr_b16 v[120:121], v136 offset:24576
  v_mfma_f32_16x16x32_bf16 v[40:43], v[104:107], v[88:91], v[40:43]
  ds_read_b64_tr_b16 v[122:123], v136 offset:25600
  ds_read_b64_tr_b16 v[124:125], v137 offset:24576
  v_mfma_f32_16x16x32_bf16 v[44:47], v[108:111], v[80:83], v[44:47]
  ds_read_b64_tr_b16 v[126:127], v137 offset:25600
  ds_read_b64_tr_b16 v[128:129], v138 offset:24576
  v_mfma_f32_16x16x32_bf16 v[48:51], v[108:111], v[84:87], v[48:51]
  ds_read_b64_tr_b16 v[130:131], v138 offset:25600
  ds_read_b64_tr_b16 v[132:133], v139 offset:24576
  v_mfma_f32_16x16x32_bf16 v[52:55], v[108:111], v[88:91], v[52:55]
  ds_read_b64_tr_b16 v[134:135], v139 offset:25600
  v_mfma_f32_16x16x32_bf16 v[56:59], v[112:115], v[80:83], v[56:59]
  v_mfma_f32_16x16x32_bf16 v[60:63], v[112:115], v[84:87], v[60:63]
  v_mfma_f32_16x16x32_bf16 v[64:67], v[112:115], v[88:91], v[64:67]
  v_mfma_f32_16x16x32_bf16 v[68:71], v[116:119], v[80:83], v[68:71]
  v_mfma_f32_16x16x32_bf16 v[72:75], v[116:119], v[84:87], v[72:75]
  v_mfma_f32_16x16x32_bf16 v[76:79], v[116:119], v[88:91], v[76:79]
  s_waitcnt lgkmcnt(0)
  s_barrier
  v_mfma_f32_16x16x32_bf16 v[32:35], v[120:123], v[92:95], v[32:35]
  ds_read_b128 v[80:83], v14 offset:0
  ds_read_b128 v[84:87], v14 offset:2048
  v_mfma_f32_16x16x32_bf16 v[36:39], v[120:123], v[96:99], v[36:39]
  ds_read_b128 v[88:91], v14 offset:4096
  ds_read_b64_tr_b16 v[104:105], v136 offset:32768
  v_mfma_f32_16x16x32_bf16 v[40:43], v[120:123], v[100:103], v[40:43]
  ds_read_b64_tr_b16 v[106:107], v136 offset:33792
  ds_read_b64_tr_b16 v[108:109], v137 offset:32768
  v_mfma_f32_16x16x32_bf16 v[44:47], v[124:127], v[92:95], v[44:47]
  ds_read_b64_tr_b16 v[110:111], v137 offset:33792
  ds_read_b64_tr_b16 v[112:113], v138 offset:32768
  v_mfma_f32_16x16x32_bf16 v[48:51], v[124:127], v[96:99], v[48:51]
  ds_read_b64_tr_b16 v[114:115], v138 offset:33792
  ds_read_b64_tr_b16 v[116:117], v139 offset:32768
  v_mfma_f32_16x16x32_bf16 v[52:55], v[124:127], v[100:103], v[52:55]
  ds_read_b64_tr_b16 v[118:119], v139 offset:33792
  v_mfma_f32_16x16x32_bf16 v[56:59], v[128:131], v[92:95], v[56:59]
  v_mfma_f32_16x16x32_bf16 v[60:63], v[128:131], v[96:99], v[60:63]
  v_mfma_f32_16x16x32_bf16 v[64:67], v[128:131], v[100:103], v[64:67]
  v_mfma_f32_16x16x32_bf16 v[68:71], v[132:135], v[92:95], v[68:71]
  v_mfma_f32_16x16x32_bf16 v[72:75], v[132:135], v[96:99], v[72:75]
  v_mfma_f32_16x16x32_bf16 v[76:79], v[132:135], v[100:103], v[76:79]
  s_waitcnt lgkmcnt(0)
  v_mfma_f32_16x16x32_bf16 v[32:35], v[104:107], v[80:83], v[32:35]
  ds_read_b128 v[92:95], v15 offset:0
  ds_read_b128 v[96:99], v15 offset:2048
  v_mfma_f32_16x16x32_bf16 v[36:39], v[104:107], v[84:87], v[36:39]
  ds_read_b128 v[100:103], v15 offset:4096
  ds_read_b64_tr_b16 v[120:121], v136 offset:40960
  v_mfma_f32_16x16x32_bf16 v[40:43], v[104:107], v[88:91], v[40:43]
  ds_read_b64_tr_b16 v[122:123], v136 offset:41984
  ds_read_b64_tr_b16 v[124:125], v137 offset:40960
  v_mfma_f32_16x16x32_bf16 v[44:47], v[108:111], v[80:83], v[44:47]
  ds_read_b64_tr_b16 v[126:127], v137 offset:41984
  ds_read_b64_tr_b16 v[128:129], v138 offset:40960
  v_mfma_f32_16x16x32_bf16 v[48:51], v[108:111], v[84:87], v[48:51]
  ds_read_b64_tr_b16 v[130:131], v138 offset:41984
  ds_read_b64_tr_b16 v[132:133], v139 offset:40960
  v_mfma_f32_16x16x32_bf16 v[52:55], v[108:111], v[88:91], v[52:55]
  ds_read_b64_tr_b16 v[134:135], v139 offset:41984
  v_mfma_f32_16x16x32_bf16 v[56:59], v[112:115], v[80:83], v[56:59]
  v_mfma_f32_16x16x32_bf16 v[60:63], v[112:115], v[84:87], v[60:63]
  v_mfma_f32_16x16x32_bf16 v[64:67], v[112:115], v[88:91], v[64:67]
  v_mfma_f32_16x16x32_bf16 v[68:71], v[116:119], v[80:83], v[68:71]
  v_mfma_f32_16x16x32_bf16 v[72:75], v[116:119], v[84:87], v[72:75]
  v_mfma_f32_16x16x32_bf16 v[76:79], v[116:119], v[88:91], v[76:79]
  s_waitcnt lgkmcnt(0)
  s_barrier
  v_mfma_f32_16x16x32_bf16 v[32:35], v[120:123], v[92:95], v[32:35]
  ds_read_b128 v[80:83], v14 offset:28672
  ds_read_b128 v[84:87], v14 offset:30720
  v_mfma_f32_16x16x32_bf16 v[36:39], v[120:123], v[96:99], v[36:39]
  ds_read_b128 v[88:91], v14 offset:32768
  ds_read_b64_tr_b16 v[104:105], v20 offset:40960
  v_mfma_f32_16x16x32_bf16 v[40:43], v[120:123], v[100:103], v[40:43]
  ds_read_b64_tr_b16 v[106:107], v20 offset:41984
  ds_read_b64_tr_b16 v[108:109], v21 offset:40960
  v_mfma_f32_16x16x32_bf16 v[44:47], v[124:127], v[92:95], v[44:47]
  ds_read_b64_tr_b16 v[110:111], v21 offset:41984
  ds_read_b64_tr_b16 v[112:113], v22 offset:40960
  v_mfma_f32_16x16x32_bf16 v[48:51], v[124:127], v[96:99], v[48:51]
  ds_read_b64_tr_b16 v[114:115], v22 offset:41984
  ds_read_b64_tr_b16 v[116:117], v23 offset:40960
  v_mfma_f32_16x16x32_bf16 v[52:55], v[124:127], v[100:103], v[52:55]
  ds_read_b64_tr_b16 v[118:119], v23 offset:41984
  v_mfma_f32_16x16x32_bf16 v[56:59], v[128:131], v[92:95], v[56:59]
  v_mfma_f32_16x16x32_bf16 v[60:63], v[128:131], v[96:99], v[60:63]
  v_mfma_f32_16x16x32_bf16 v[64:67], v[128:131], v[100:103], v[64:67]
  v_mfma_f32_16x16x32_bf16 v[68:71], v[132:135], v[92:95], v[68:71]
  v_mfma_f32_16x16x32_bf16 v[72:75], v[132:135], v[96:99], v[72:75]
  v_mfma_f32_16x16x32_bf16 v[76:79], v[132:135], v[100:103], v[76:79]
  s_waitcnt lgkmcnt(0)
  v_mfma_f32_16x16x32_bf16 v[32:35], v[104:107], v[80:83], v[32:35]
  ds_read_b128 v[92:95], v15 offset:28672
  ds_read_b128 v[96:99], v15 offset:30720
  v_mfma_f32_16x16x32_bf16 v[36:39], v[104:107], v[84:87], v[36:39]
  ds_read_b128 v[100:103], v15 offset:32768
  ds_read_b64_tr_b16 v[120:121], v20 offset:49152
  v_mfma_f32_16x16x32_bf16 v[40:43], v[104:107], v[88:91], v[40:43]
  ds_read_b64_tr_b16 v[122:123], v20 offset:50176
  ds_read_b64_tr_b16 v[124:125], v21 offset:49152
  v_mfma_f32_16x16x32_bf16 v[44:47], v[108:111], v[80:83], v[44:47]
  ds_read_b64_tr_b16 v[126:127], v21 offset:50176
  ds_read_b64_tr_b16 v[128:129], v22 offset:49152
  v_mfma_f32_16x16x32_bf16 v[48:51], v[108:111], v[84:87], v[48:51]
  ds_read_b64_tr_b16 v[130:131], v22 offset:50176
  ds_read_b64_tr_b16 v[132:133], v23 offset:49152
  v_mfma_f32_16x16x32_bf16 v[52:55], v[108:111], v[88:91], v[52:55]
  ds_read_b64_tr_b16 v[134:135], v23 offset:50176
  v_mfma_f32_16x16x32_bf16 v[56:59], v[112:115], v[80:83], v[56:59]
  v_mfma_f32_16x16x32_bf16 v[60:63], v[112:115], v[84:87], v[60:63]
  v_mfma_f32_16x16x32_bf16 v[64:67], v[112:115], v[88:91], v[64:67]
  v_mfma_f32_16x16x32_bf16 v[68:71], v[116:119], v[80:83], v[68:71]
  v_mfma_f32_16x16x32_bf16 v[72:75], v[116:119], v[84:87], v[72:75]
  v_mfma_f32_16x16x32_bf16 v[76:79], v[116:119], v[88:91], v[76:79]
  s_waitcnt lgkmcnt(0)
  s_barrier
  v_mfma_f32_16x16x32_bf16 v[32:35], v[120:123], v[92:95], v[32:35]
  ds_read_b128 v[80:83], v12 offset:0
  ds_read_b128 v[84:87], v12 offset:2048
  v_mfma_f32_16x16x32_bf16 v[36:39], v[120:123], v[96:99], v[36:39]
  ds_read_b128 v[88:91], v12 offset:4096
  ds_read_b64_tr_b16 v[104:105], v16 offset:12288
  v_mfma_f32_16x16x32_bf16 v[40:43], v[120:123], v[100:103], v[40:43]
  ds_read_b64_tr_b16 v[106:107], v16 offset:13312
  ds_read_b64_tr_b16 v[108:109], v17 offset:12288
  v_mfma_f32_16x16x32_bf16 v[44:47], v[124:127], v[92:95], v[44:47]
  ds_read_b64_tr_b16 v[110:111], v17 offset:13312
  ds_read_b64_tr_b16 v[112:113], v18 offset:12288
  v_mfma_f32_16x16x32_bf16 v[48:51], v[124:127], v[96:99], v[48:51]
  ds_read_b64_tr_b16 v[114:115], v18 offset:13312
  ds_read_b64_tr_b16 v[116:117], v19 offset:12288
  v_mfma_f32_16x16x32_bf16 v[52:55], v[124:127], v[100:103], v[52:55]
  ds_read_b64_tr_b16 v[118:119], v19 offset:13312
  v_mfma_f32_16x16x32_bf16 v[56:59], v[128:131], v[92:95], v[56:59]
  v_mfma_f32_16x16x32_bf16 v[60:63], v[128:131], v[96:99], v[60:63]
  v_mfma_f32_16x16x32_bf16 v[64:67], v[128:131], v[100:103], v[64:67]
  v_mfma_f32_16x16x32_bf16 v[68:71], v[132:135], v[92:95], v[68:71]
  v_mfma_f32_16x16x32_bf16 v[72:75], v[132:135], v[96:99], v[72:75]
  v_mfma_f32_16x16x32_bf16 v[76:79], v[132:135], v[100:103], v[76:79]
  s_waitcnt lgkmcnt(0)
  v_mfma_f32_16x16x32_bf16 v[32:35], v[104:107], v[80:83], v[32:35]
  ds_read_b128 v[92:95], v13 offset:0
  ds_read_b128 v[96:99], v13 offset:2048
  v_mfma_f32_16x16x32_bf16 v[36:39], v[104:107], v[84:87], v[36:39]
  ds_read_b128 v[100:103], v13 offset:4096
  ds_read_b64_tr_b16 v[120:121], v16 offset:20480
  v_mfma_f32_16x16x32_bf16 v[40:43], v[104:107], v[88:91], v[40:43]
  ds_read_b64_tr_b16 v[122:123], v16 offset:21504
  ds_read_b64_tr_b16 v[124:125], v17 offset:20480
  v_mfma_f32_16x16x32_bf16 v[44:47], v[108:111], v[80:83], v[44:47]
  ds_read_b64_tr_b16 v[126:127], v17 offset:21504
  ds_read_b64_tr_b16 v[128:129], v18 offset:20480
  v_mfma_f32_16x16x32_bf16 v[48:51], v[108:111], v[84:87], v[48:51]
  ds_read_b64_tr_b16 v[130:131], v18 offset:21504
  ds_read_b64_tr_b16 v[132:133], v19 offset:20480
  v_mfma_f32_16x16x32_bf16 v[52:55], v[108:111], v[88:91], v[52:55]
  ds_read_b64_tr_b16 v[134:135], v19 offset:21504
  v_mfma_f32_16x16x32_bf16 v[56:59], v[112:115], v[80:83], v[56:59]
  v_mfma_f32_16x16x32_bf16 v[60:63], v[112:115], v[84:87], v[60:63]
  v_mfma_f32_16x16x32_bf16 v[64:67], v[112:115], v[88:91], v[64:67]
  v_mfma_f32_16x16x32_bf16 v[68:71], v[116:119], v[80:83], v[68:71]
  v_mfma_f32_16x16x32_bf16 v[72:75], v[116:119], v[84:87], v[72:75]
  v_mfma_f32_16x16x32_bf16 v[76:79], v[116:119], v[88:91], v[76:79]
  s_waitcnt lgkmcnt(0)
  s_barrier
  v_mfma_f32_16x16x32_bf16 v[32:35], v[120:123], v[92:95], v[32:35]
  ds_read_b128 v[80:83], v12 offset:28672
  ds_read_b128 v[84:87], v12 offset:30720
  v_mfma_f32_16x16x32_bf16 v[36:39], v[120:123], v[96:99], v[36:39]
  ds_read_b128 v[88:91], v12 offset:32768
  ds_read_b64_tr_b16 v[104:105], v16 offset:40960
  v_mfma_f32_16x16x32_bf16 v[40:43], v[120:123], v[100:103], v[40:43]
  ds_read_b64_tr_b16 v[106:107], v16 offset:41984
  ds_read_b64_tr_b16 v[108:109], v17 offset:40960
  v_mfma_f32_16x16x32_bf16 v[44:47], v[124:127], v[92:95], v[44:47]
  ds_read_b64_tr_b16 v[110:111], v17 offset:41984
  ds_read_b64_tr_b16 v[112:113], v18 offset:40960
  v_mfma_f32_16x16x32_bf16 v[48:51], v[124:127], v[96:99], v[48:51]
  ds_read_b64_tr_b16 v[114:115], v18 offset:41984
  ds_read_b64_tr_b16 v[116:117], v19 offset:40960
  v_mfma_f32_16x16x32_bf16 v[52:55], v[124:127], v[100:103], v[52:55]
  ds_read_b64_tr_b16 v[118:119], v19 offset:41984
  v_mfma_f32_16x16x32_bf16 v[56:59], v[128:131], v[92:95], v[56:59]
  v_mfma_f32_16x16x32_bf16 v[60:63], v[128:131], v[96:99], v[60:63]
  v_mfma_f32_16x16x32_bf16 v[64:67], v[128:131], v[100:103], v[64:67]
  v_mfma_f32_16x16x32_bf16 v[68:71], v[132:135], v[92:95], v[68:71]
  v_mfma_f32_16x16x32_bf16 v[72:75], v[132:135], v[96:99], v[72:75]
  v_mfma_f32_16x16x32_bf16 v[76:79], v[132:135], v[100:103], v[76:79]
  s_waitcnt lgkmcnt(0)
  v_mfma_f32_16x16x32_bf16 v[32:35], v[104:107], v[80:83], v[32:35]
  ds_read_b128 v[92:95], v13 offset:28672
  ds_read_b128 v[96:99], v13 offset:30720
  v_mfma_f32_16x16x32_bf16 v[36:39], v[104:107], v[84:87], v[36:39]
  ds_read_b128 v[100:103], v13 offset:32768
  ds_read_b64_tr_b16 v[120:121], v16 offset:49152
  v_mfma_f32_16x16x32_bf16 v[40:43], v[104:107], v[88:91], v[40:43]
  ds_read_b64_tr_b16 v[122:123], v16 offset:50176
  ds_read_b64_tr_b16 v[124:125], v17 offset:49152
  v_mfma_f32_16x16x32_bf16 v[44:47], v[108:111], v[80:83], v[44:47]
  ds_read_b64_tr_b16 v[126:127], v17 offset:50176
  ds_read_b64_tr_b16 v[128:129], v18 offset:49152
  v_mfma_f32_16x16x32_bf16 v[48:51], v[108:111], v[84:87], v[48:51]
  ds_read_b64_tr_b16 v[130:131], v18 offset:50176
  ds_read_b64_tr_b16 v[132:133], v19 offset:49152
  v_mfma_f32_16x16x32_bf16 v[52:55], v[108:111], v[88:91], v[52:55]
  ds_read_b64_tr_b16 v[134:135], v19 offset:50176
  v_mfma_f32_16x16x32_bf16 v[56:59], v[112:115], v[80:83], v[56:59]
  v_mfma_f32_16x16x32_bf16 v[60:63], v[112:115], v[84:87], v[60:63]
  v_mfma_f32_16x16x32_bf16 v[64:67], v[112:115], v[88:91], v[64:67]
  v_mfma_f32_16x16x32_bf16 v[68:71], v[116:119], v[80:83], v[68:71]
  v_mfma_f32_16x16x32_bf16 v[72:75], v[116:119], v[84:87], v[72:75]
  v_mfma_f32_16x16x32_bf16 v[76:79], v[116:119], v[88:91], v[76:79]
  s_waitcnt lgkmcnt(0)
  s_barrier
  v_mfma_f32_16x16x32_bf16 v[32:35], v[120:123], v[92:95], v[32:35]
  ds_read_b128 v[80:83], v14 offset:0
  ds_read_b128 v[84:87], v14 offset:2048
  v_mfma_f32_16x16x32_bf16 v[36:39], v[120:123], v[96:99], v[36:39]
  ds_read_b128 v[88:91], v14 offset:4096
  ds_read_b64_tr_b16 v[104:105], v20 offset:12288
  v_mfma_f32_16x16x32_bf16 v[40:43], v[120:123], v[100:103], v[40:43]
  ds_read_b64_tr_b16 v[106:107], v20 offset:13312
  ds_read_b64_tr_b16 v[108:109], v21 offset:12288
  v_mfma_f32_16x16x32_bf16 v[44:47], v[124:127], v[92:95], v[44:47]
  ds_read_b64_tr_b16 v[110:111], v21 offset:13312
  ds_read_b64_tr_b16 v[112:113], v22 offset:12288
  v_mfma_f32_16x16x32_bf16 v[48:51], v[124:127], v[96:99], v[48:51]
  ds_read_b64_tr_b16 v[114:115], v22 offset:13312
  ds_read_b64_tr_b16 v[116:117], v23 offset:12288
  v_mfma_f32_16x16x32_bf16 v[52:55], v[124:127], v[100:103], v[52:55]
  ds_read_b64_tr_b16 v[118:119], v23 offset:13312
  v_mfma_f32_16x16x32_bf16 v[56:59], v[128:131], v[92:95], v[56:59]
  v_mfma_f32_16x16x32_bf16 v[60:63], v[128:131], v[96:99], v[60:63]
  v_mfma_f32_16x16x32_bf16 v[64:67], v[128:131], v[100:103], v[64:67]
  v_mfma_f32_16x16x32_bf16 v[68:71], v[132:135], v[92:95], v[68:71]
  v_mfma_f32_16x16x32_bf16 v[72:75], v[132:135], v[96:99], v[72:75]
  v_mfma_f32_16x16x32_bf16 v[76:79], v[132:135], v[100:103], v[76:79]
  s_waitcnt lgkmcnt(0)
  v_mfma_f32_16x16x32_bf16 v[32:35], v[104:107], v[80:83], v[32:35]
  ds_read_b128 v[92:95], v15 offset:0
  ds_read_b128 v[96:99], v15 offset:2048
  v_mfma_f32_16x16x32_bf16 v[36:39], v[104:107], v[84:87], v[36:39]
  ds_read_b128 v[100:103], v15 offset:4096
  ds_read_b64_tr_b16 v[120:121], v20 offset:20480
  v_mfma_f32_16x16x32_bf16 v[40:43], v[104:107], v[88:91], v[40:43]
  ds_read_b64_tr_b16 v[122:123], v20 offset:21504
  ds_read_b64_tr_b16 v[124:125], v21 offset:20480
  v_mfma_f32_16x16x32_bf16 v[44:47], v[108:111], v[80:83], v[44:47]
  ds_read_b64_tr_b16 v[126:127], v21 offset:21504
  ds_read_b64_tr_b16 v[128:129], v22 offset:20480
  v_mfma_f32_16x16x32_bf16 v[48:51], v[108:111], v[84:87], v[48:51]
  ds_read_b64_tr_b16 v[130:131], v22 offset:21504
  ds_read_b64_tr_b16 v[132:133], v23 offset:20480
  v_mfma_f32_16x16x32_bf16 v[52:55], v[108:111], v[88:91], v[52:55]
  ds_read_b64_tr_b16 v[134:135], v23 offset:21504
  v_mfma_f32_16x16x32_bf16 v[56:59], v[112:115], v[80:83], v[56:59]
  v_mfma_f32_16x16x32_bf16 v[60:63], v[112:115], v[84:87], v[60:63]
  v_mfma_f32_16x16x32_bf16 v[64:67], v[112:115], v[88:91], v[64:67]
  v_mfma_f32_16x16x32_bf16 v[68:71], v[116:119], v[80:83], v[68:71]
  v_mfma_f32_16x16x32_bf16 v[72:75], v[116:119], v[84:87], v[72:75]
  v_mfma_f32_16x16x32_bf16 v[76:79], v[116:119], v[88:91], v[76:79]
  s_waitcnt lgkmcnt(0)
  s_barrier
  v_mfma_f32_16x16x32_bf16 v[32:35], v[120:123], v[92:95], v[32:35]
  ds_read_b128 v[80:83], v14 offset:28672
  ds_read_b128 v[84:87], v14 offset:30720
  v_mfma_f32_16x16x32_bf16 v[36:39], v[120:123], v[96:99], v[36:39]
  ds_read_b128 v[88:91], v14 offset:32768
  ds_read_b64_tr_b16 v[104:105], v20 offset:40960
  v_mfma_f32_16x16x32_bf16 v[40:43], v[120:123], v[100:103], v[40:43]
  ds_read_b64_tr_b16 v[106:107], v20 offset:41984
  ds_read_b64_tr_b16 v[108:109], v21 offset:40960
  v_mfma_f32_16x16x32_bf16 v[44:47], v[124:127], v[92:95], v[44:47]
  ds_read_b64_tr_b16 v[110:111], v21 offset:41984
  ds_read_b64_tr_b16 v[112:113], v22 offset:40960
  v_mfma_f32_16x16x32_bf16 v[48:51], v[124:127], v[96:99], v[48:51]
  ds_read_b64_tr_b16 v[114:115], v22 offset:41984
  ds_read_b64_tr_b16 v[116:117], v23 offset:40960
  v_mfma_f32_16x16x32_bf16 v[52:55], v[124:127], v[100:103], v[52:55]
  ds_read_b64_tr_b16 v[118:119], v23 offset:41984
  v_mfma_f32_16x16x32_bf16 v[56:59], v[128:131], v[92:95], v[56:59]
  v_mfma_f32_16x16x32_bf16 v[60:63], v[128:131], v[96:99], v[60:63]
  v_mfma_f32_16x16x32_bf16 v[64:67], v[128:131], v[100:103], v[64:67]
  v_mfma_f32_16x16x32_bf16 v[68:71], v[132:135], v[92:95], v[68:71]
  v_mfma_f32_16x16x32_bf16 v[72:75], v[132:135], v[96:99], v[72:75]
  v_mfma_f32_16x16x32_bf16 v[76:79], v[132:135], v[100:103], v[76:79]
  s_waitcnt lgkmcnt(0)
  v_mfma_f32_16x16x32_bf16 v[32:35], v[104:107], v[80:83], v[32:35]
  ds_read_b128 v[92:95], v15 offset:28672
  ds_read_b128 v[96:99], v15 offset:30720
  v_mfma_f32_16x16x32_bf16 v[36:39], v[104:107], v[84:87], v[36:39]
  ds_read_b128 v[100:103], v15 offset:32768
  ds_read_b64_tr_b16 v[120:121], v20 offset:49152
  v_mfma_f32_16x16x32_bf16 v[40:43], v[104:107], v[88:91], v[40:43]
  ds_read_b64_tr_b16 v[122:123], v20 offset:50176
  ds_read_b64_tr_b16 v[124:125], v21 offset:49152
  v_mfma_f32_16x16x32_bf16 v[44:47], v[108:111], v[80:83], v[44:47]
  ds_read_b64_tr_b16 v[126:127], v21 offset:50176
  ds_read_b64_tr_b16 v[128:129], v22 offset:49152
  v_mfma_f32_16x16x32_bf16 v[48:51], v[108:111], v[84:87], v[48:51]
  ds_read_b64_tr_b16 v[130:131], v22 offset:50176
  ds_read_b64_tr_b16 v[132:133], v23 offset:49152
  v_mfma_f32_16x16x32_bf16 v[52:55], v[108:111], v[88:91], v[52:55]
  ds_read_b64_tr_b16 v[134:135], v23 offset:50176
  v_mfma_f32_16x16x32_bf16 v[56:59], v[112:115], v[80:83], v[56:59]
  v_mfma_f32_16x16x32_bf16 v[60:63], v[112:115], v[84:87], v[60:63]
  v_mfma_f32_16x16x32_bf16 v[64:67], v[112:115], v[88:91], v[64:67]
  v_mfma_f32_16x16x32_bf16 v[68:71], v[116:119], v[80:83], v[68:71]
  v_mfma_f32_16x16x32_bf16 v[72:75], v[116:119], v[84:87], v[72:75]
  v_mfma_f32_16x16x32_bf16 v[76:79], v[116:119], v[88:91], v[76:79]
  s_waitcnt lgkmcnt(0)
  s_barrier
  v_mfma_f32_16x16x32_bf16 v[32:35], v[120:123], v[92:95], v[32:35]
  ds_read_b128 v[80:83], v12 offset:0
  ds_read_b128 v[84:87], v12 offset:2048
  v_mfma_f32_16x16x32_bf16 v[36:39], v[120:123], v[96:99], v[36:39]
  ds_read_b128 v[88:91], v12 offset:4096
  ds_read_b64_tr_b16 v[104:105], v16 offset:12288
  v_mfma_f32_16x16x32_bf16 v[40:43], v[120:123], v[100:103], v[40:43]
  ds_read_b64_tr_b16 v[106:107], v16 offset:13312
  ds_read_b64_tr_b16 v[108:109], v17 offset:12288
  v_mfma_f32_16x16x32_bf16 v[44:47], v[124:127], v[92:95], v[44:47]
  ds_read_b64_tr_b16 v[110:111], v17 offset:13312
  ds_read_b64_tr_b16 v[112:113], v18 offset:12288
  v_mfma_f32_16x16x32_bf16 v[48:51], v[124:127], v[96:99], v[48:51]
  ds_read_b64_tr_b16 v[114:115], v18 offset:13312
  ds_read_b64_tr_b16 v[116:117], v19 offset:12288
  v_mfma_f32_16x16x32_bf16 v[52:55], v[124:127], v[100:103], v[52:55]
  ds_read_b64_tr_b16 v[118:119], v19 offset:13312
  v_mfma_f32_16x16x32_bf16 v[56:59], v[128:131], v[92:95], v[56:59]
  v_mfma_f32_16x16x32_bf16 v[60:63], v[128:131], v[96:99], v[60:63]
  v_mfma_f32_16x16x32_bf16 v[64:67], v[128:131], v[100:103], v[64:67]
  v_mfma_f32_16x16x32_bf16 v[68:71], v[132:135], v[92:95], v[68:71]
  v_mfma_f32_16x16x32_bf16 v[72:75], v[132:135], v[96:99], v[72:75]
  v_mfma_f32_16x16x32_bf16 v[76:79], v[132:135], v[100:103], v[76:79]
  s_waitcnt lgkmcnt(0)
  v_mfma_f32_16x16x32_bf16 v[32:35], v[104:107], v[80:83], v[32:35]
  ds_read_b128 v[92:95], v13 offset:0
  ds_read_b128 v[96:99], v13 offset:2048
  v_mfma_f32_16x16x32_bf16 v[36:39], v[104:107], v[84:87], v[36:39]
  ds_read_b128 v[100:103], v13 offset:4096
  ds_read_b64_tr_b16 v[120:121], v16 offset:20480
  v_mfma_f32_16x16x32_bf16 v[40:43], v[104:107], v[88:91], v[40:43]
  ds_read_b64_tr_b16 v[122:123], v16 offset:21504
  ds_read_b64_tr_b16 v[124:125], v17 offset:20480
  v_mfma_f32_16x16x32_bf16 v[44:47], v[108:111], v[80:83], v[44:47]
  ds_read_b64_tr_b16 v[126:127], v17 offset:21504
  ds_read_b64_tr_b16 v[128:129], v18 offset:20480
  v_mfma_f32_16x16x32_bf16 v[48:51], v[108:111], v[84:87], v[48:51]
  ds_read_b64_tr_b16 v[130:131], v18 offset:21504
  ds_read_b64_tr_b16 v[132:133], v19 offset:20480
  v_mfma_f32_16x16x32_bf16 v[52:55], v[108:111], v[88:91], v[52:55]
  ds_read_b64_tr_b16 v[134:135], v19 offset:21504
  v_mfma_f32_16x16x32_bf16 v[56:59], v[112:115], v[80:83], v[56:59]
  v_mfma_f32_16x16x32_bf16 v[60:63], v[112:115], v[84:87], v[60:63]
  v_mfma_f32_16x16x32_bf16 v[64:67], v[112:115], v[88:91], v[64:67]
  v_mfma_f32_16x16x32_bf16 v[68:71], v[116:119], v[80:83], v[68:71]
  v_mfma_f32_16x16x32_bf16 v[72:75], v[116:119], v[84:87], v[72:75]
  v_mfma_f32_16x16x32_bf16 v[76:79], v[116:119], v[88:91], v[76:79]
  s_waitcnt lgkmcnt(0)
  s_barrier
  v_mfma_f32_16x16x32_bf16 v[32:35], v[120:123], v[92:95], v[32:35]
  ds_read_b128 v[80:83], v12 offset:28672
  ds_read_b128 v[84:87], v12 offset:30720
  v_mfma_f32_16x16x32_bf16 v[36:39], v[120:123], v[96:99], v[36:39]
  ds_read_b128 v[88:91], v12 offset:32768
  ds_read_b64_tr_b16 v[104:105], v16 offset:40960
  v_mfma_f32_16x16x32_bf16 v[40:43], v[120:123], v[100:103], v[40:43]
  ds_read_b64_tr_b16 v[106:107], v16 offset:41984
  ds_read_b64_tr_b16 v[108:109], v17 offset:40960
  v_mfma_f32_16x16x32_bf16 v[44:47], v[124:127], v[92:95], v[44:47]
  ds_read_b64_tr_b16 v[110:111], v17 offset:41984
  ds_read_b64_tr_b16 v[112:113], v18 offset:40960
  v_mfma_f32_16x16x32_bf16 v[48:51], v[124:127], v[96:99], v[48:51]
  ds_read_b64_tr_b16 v[114:115], v18 offset:41984
  ds_read_b64_tr_b16 v[116:117], v19 offset:40960
  v_mfma_f32_16x16x32_bf16 v[52:55], v[124:127], v[100:103], v[52:55]
  ds_read_b64_tr_b16 v[118:119], v19 offset:41984
  v_mfma_f32_16x16x32_bf16 v[56:59], v[128:131], v[92:95], v[56:59]
  v_mfma_f32_16x16x32_bf16 v[60:63], v[128:131], v[96:99], v[60:63]
  v_mfma_f32_16x16x32_bf16 v[64:67], v[128:131], v[100:103], v[64:67]
  v_mfma_f32_16x16x32_bf16 v[68:71], v[132:135], v[92:95], v[68:71]
  v_mfma_f32_16x16x32_bf16 v[72:75], v[132:135], v[96:99], v[72:75]
  v_mfma_f32_16x16x32_bf16 v[76:79], v[132:135], v[100:103], v[76:79]
  s_waitcnt lgkmcnt(0)
  v_mfma_f32_16x16x32_bf16 v[32:35], v[104:107], v[80:83], v[32:35]
  ds_read_b128 v[92:95], v13 offset:28672
  ds_read_b128 v[96:99], v13 offset:30720
  v_mfma_f32_16x16x32_bf16 v[36:39], v[104:107], v[84:87], v[36:39]
  ds_read_b128 v[100:103], v13 offset:32768
  ds_read_b64_tr_b16 v[120:121], v16 offset:49152
  v_mfma_f32_16x16x32_bf16 v[40:43], v[104:107], v[88:91], v[40:43]
  ds_read_b64_tr_b16 v[122:123], v16 offset:50176
  ds_read_b64_tr_b16 v[124:125], v17 offset:49152
  v_mfma_f32_16x16x32_bf16 v[44:47], v[108:111], v[80:83], v[44:47]
  ds_read_b64_tr_b16 v[126:127], v17 offset:50176
  ds_read_b64_tr_b16 v[128:129], v18 offset:49152
  v_mfma_f32_16x16x32_bf16 v[48:51], v[108:111], v[84:87], v[48:51]
  ds_read_b64_tr_b16 v[130:131], v18 offset:50176
  ds_read_b64_tr_b16 v[132:133], v19 offset:49152
  v_mfma_f32_16x16x32_bf16 v[52:55], v[108:111], v[88:91], v[52:55]
  ds_read_b64_tr_b16 v[134:135], v19 offset:50176
  v_mfma_f32_16x16x32_bf16 v[56:59], v[112:115], v[80:83], v[56:59]
  v_mfma_f32_16x16x32_bf16 v[60:63], v[112:115], v[84:87], v[60:63]
  v_mfma_f32_16x16x32_bf16 v[64:67], v[112:115], v[88:91], v[64:67]
  v_mfma_f32_16x16x32_bf16 v[68:71], v[116:119], v[80:83], v[68:71]
  v_mfma_f32_16x16x32_bf16 v[72:75], v[116:119], v[84:87], v[72:75]
  v_mfma_f32_16x16x32_bf16 v[76:79], v[116:119], v[88:91], v[76:79]
  s_waitcnt lgkmcnt(0)
  s_barrier
  v_mfma_f32_16x16x32_bf16 v[32:35], v[120:123], v[92:95], v[32:35]
  ds_read_b128 v[80:83], v14 offset:0
  ds_read_b128 v[84:87], v14 offset:2048
  v_mfma_f32_16x16x32_bf16 v[36:39], v[120:123], v[96:99], v[36:39]
  ds_read_b128 v[88:91], v14 offset:4096
  ds_read_b64_tr_b16 v[104:105], v20 offset:12288
  v_mfma_f32_16x16x32_bf16 v[40:43], v[120:123], v[100:103], v[40:43]
  ds_read_b64_tr_b16 v[106:107], v20 offset:13312
  ds_read_b64_tr_b16 v[108:109], v21 offset:12288
  v_mfma_f32_16x16x32_bf16 v[44:47], v[124:127], v[92:95], v[44:47]
  ds_read_b64_tr_b16 v[110:111], v21 offset:13312
  ds_read_b64_tr_b16 v[112:113], v22 offset:12288
  v_mfma_f32_16x16x32_bf16 v[48:51], v[124:127], v[96:99], v[48:51]
  ds_read_b64_tr_b16 v[114:115], v22 offset:13312
  ds_read_b64_tr_b16 v[116:117], v23 offset:12288
  v_mfma_f32_16x16x32_bf16 v[52:55], v[124:127], v[100:103], v[52:55]
  ds_read_b64_tr_b16 v[118:119], v23 offset:13312
  v_mfma_f32_16x16x32_bf16 v[56:59], v[128:131], v[92:95], v[56:59]
  v_mfma_f32_16x16x32_bf16 v[60:63], v[128:131], v[96:99], v[60:63]
  v_mfma_f32_16x16x32_bf16 v[64:67], v[128:131], v[100:103], v[64:67]
  v_mfma_f32_16x16x32_bf16 v[68:71], v[132:135], v[92:95], v[68:71]
  v_mfma_f32_16x16x32_bf16 v[72:75], v[132:135], v[96:99], v[72:75]
  v_mfma_f32_16x16x32_bf16 v[76:79], v[132:135], v[100:103], v[76:79]
  s_waitcnt lgkmcnt(0)
  v_mfma_f32_16x16x32_bf16 v[32:35], v[104:107], v[80:83], v[32:35]
  ds_read_b128 v[92:95], v15 offset:0
  ds_read_b128 v[96:99], v15 offset:2048
  v_mfma_f32_16x16x32_bf16 v[36:39], v[104:107], v[84:87], v[36:39]
  ds_read_b128 v[100:103], v15 offset:4096
  ds_read_b64_tr_b16 v[120:121], v20 offset:20480
  v_mfma_f32_16x16x32_bf16 v[40:43], v[104:107], v[88:91], v[40:43]
  ds_read_b64_tr_b16 v[122:123], v20 offset:21504
  ds_read_b64_tr_b16 v[124:125], v21 offset:20480
  v_mfma_f32_16x16x32_bf16 v[44:47], v[108:111], v[80:83], v[44:47]
  ds_read_b64_tr_b16 v[126:127], v21 offset:21504
  ds_read_b64_tr_b16 v[128:129], v22 offset:20480
  v_mfma_f32_16x16x32_bf16 v[48:51], v[108:111], v[84:87], v[48:51]
  ds_read_b64_tr_b16 v[130:131], v22 offset:21504
  ds_read_b64_tr_b16 v[132:133], v23 offset:20480
  v_mfma_f32_16x16x32_bf16 v[52:55], v[108:111], v[88:91], v[52:55]
  ds_read_b64_tr_b16 v[134:135], v23 offset:21504
  v_mfma_f32_16x16x32_bf16 v[56:59], v[112:115], v[80:83], v[56:59]
  v_mfma_f32_16x16x32_bf16 v[60:63], v[112:115], v[84:87], v[60:63]
  v_mfma_f32_16x16x32_bf16 v[64:67], v[112:115], v[88:91], v[64:67]
  v_mfma_f32_16x16x32_bf16 v[68:71], v[116:119], v[80:83], v[68:71]
  v_mfma_f32_16x16x32_bf16 v[72:75], v[116:119], v[84:87], v[72:75]
  v_mfma_f32_16x16x32_bf16 v[76:79], v[116:119], v[88:91], v[76:79]
  s_waitcnt lgkmcnt(0)
  s_barrier
  v_mfma_f32_16x16x32_bf16 v[32:35], v[120:123], v[92:95], v[32:35]
  ds_read_b128 v[80:83], v14 offset:28672
  ds_read_b128 v[84:87], v14 offset:30720
  v_mfma_f32_16x16x32_bf16 v[36:39], v[120:123], v[96:99], v[36:39]
  ds_read_b128 v[88:91], v14 offset:32768
  ds_read_b64_tr_b16 v[104:105], v20 offset:40960
  v_mfma_f32_16x16x32_bf16 v[40:43], v[120:123], v[100:103], v[40:43]
  ds_read_b64_tr_b16 v[106:107], v20 offset:41984
  ds_read_b64_tr_b16 v[108:109], v21 offset:40960
  v_mfma_f32_16x16x32_bf16 v[44:47], v[124:127], v[92:95], v[44:47]
  ds_read_b64_tr_b16 v[110:111], v21 offset:41984
  ds_read_b64_tr_b16 v[112:113], v22 offset:40960
  v_mfma_f32_16x16x32_bf16 v[48:51], v[124:127], v[96:99], v[48:51]
  ds_read_b64_tr_b16 v[114:115], v22 offset:41984
  ds_read_b64_tr_b16 v[116:117], v23 offset:40960
  v_mfma_f32_16x16x32_bf16 v[52:55], v[124:127], v[100:103], v[52:55]
  ds_read_b64_tr_b16 v[118:119], v23 offset:41984
  v_mfma_f32_16x16x32_bf16 v[56:59], v[128:131], v[92:95], v[56:59]
  v_mfma_f32_16x16x32_bf16 v[60:63], v[128:131], v[96:99], v[60:63]
  v_mfma_f32_16x16x32_bf16 v[64:67], v[128:131], v[100:103], v[64:67]
  v_mfma_f32_16x16x32_bf16 v[68:71], v[132:135], v[92:95], v[68:71]
  v_mfma_f32_16x16x32_bf16 v[72:75], v[132:135], v[96:99], v[72:75]
  v_mfma_f32_16x16x32_bf16 v[76:79], v[132:135], v[100:103], v[76:79]
  s_waitcnt lgkmcnt(0)
  v_mfma_f32_16x16x32_bf16 v[32:35], v[104:107], v[80:83], v[32:35]
  ds_read_b128 v[92:95], v15 offset:28672
  ds_read_b128 v[96:99], v15 offset:30720
  v_mfma_f32_16x16x32_bf16 v[36:39], v[104:107], v[84:87], v[36:39]
  ds_read_b128 v[100:103], v15 offset:32768
  ds_read_b64_tr_b16 v[120:121], v20 offset:49152
  v_mfma_f32_16x16x32_bf16 v[40:43], v[104:107], v[88:91], v[40:43]
  ds_read_b64_tr_b16 v[122:123], v20 offset:50176
  ds_read_b64_tr_b16 v[124:125], v21 offset:49152
  v_mfma_f32_16x16x32_bf16 v[44:47], v[108:111], v[80:83], v[44:47]
  ds_read_b64_tr_b16 v[126:127], v21 offset:50176
  ds_read_b64_tr_b16 v[128:129], v22 offset:49152
  v_mfma_f32_16x16x32_bf16 v[48:51], v[108:111], v[84:87], v[48:51]
  ds_read_b64_tr_b16 v[130:131], v22 offset:50176
  ds_read_b64_tr_b16 v[132:133], v23 offset:49152
  v_mfma_f32_16x16x32_bf16 v[52:55], v[108:111], v[88:91], v[52:55]
  ds_read_b64_tr_b16 v[134:135], v23 offset:50176
  v_mfma_f32_16x16x32_bf16 v[56:59], v[112:115], v[80:83], v[56:59]
  v_mfma_f32_16x16x32_bf16 v[60:63], v[112:115], v[84:87], v[60:63]
  v_mfma_f32_16x16x32_bf16 v[64:67], v[112:115], v[88:91], v[64:67]
  v_mfma_f32_16x16x32_bf16 v[68:71], v[116:119], v[80:83], v[68:71]
  v_mfma_f32_16x16x32_bf16 v[72:75], v[116:119], v[84:87], v[72:75]
  v_mfma_f32_16x16x32_bf16 v[76:79], v[116:119], v[88:91], v[76:79]
  s_waitcnt lgkmcnt(0)
  s_barrier
  v_mfma_f32_16x16x32_bf16 v[32:35], v[120:123], v[92:95], v[32:35]
  v_mfma_f32_16x16x32_bf16 v[36:39], v[120:123], v[96:99], v[36:39]
  v_mfma_f32_16x16x32_bf16 v[40:43], v[120:123], v[100:103], v[40:43]
  v_mfma_f32_16x16x32_bf16 v[44:47], v[124:127], v[92:95], v[44:47]
  v_mfma_f32_16x16x32_bf16 v[48:51], v[124:127], v[96:99], v[48:51]
  v_mfma_f32_16x16x32_bf16 v[52:55], v[124:127], v[100:103], v[52:55]
  v_mfma_f32_16x16x32_bf16 v[56:59], v[128:131], v[92:95], v[56:59]
  v_mfma_f32_16x16x32_bf16 v[60:63], v[128:131], v[96:99], v[60:63]
  v_mfma_f32_16x16x32_bf16 v[64:67], v[128:131], v[100:103], v[64:67]
  v_mfma_f32_16x16x32_bf16 v[68:71], v[132:135], v[92:95], v[68:71]
  v_mfma_f32_16x16x32_bf16 v[72:75], v[132:135], v[96:99], v[72:75]
  v_mfma_f32_16x16x32_bf16 v[76:79], v[132:135], v[100:103], v[76:79]
  s_mov_b32 s47, 0x0d800000
  v_max3_f32 v86, |v32|, |v33|, |v34|
  v_max3_f32 v94, |v44|, |v45|, |v46|
  v_max3_f32 v102, |v56|, |v57|, |v58|
  s_nop 1
  v_max3_f32 v110, |v68|, |v69|, |v70|
  v_max3_f32 v86, v86, |v35|, |v36|
  v_max3_f32 v94, v94, |v47|, |v48|
  v_max3_f32 v102, v102, |v59|, |v60|
  v_max3_f32 v110, v110, |v71|, |v72|
  v_max3_f32 v86, v86, |v37|, |v38|
  v_max3_f32 v94, v94, |v49|, |v50|
  v_max3_f32 v102, v102, |v61|, |v62|
  v_max3_f32 v110, v110, |v73|, |v74|
  v_max3_f32 v86, v86, |v39|, |v40|
  v_max3_f32 v94, v94, |v51|, |v52|
  v_max3_f32 v102, v102, |v63|, |v64|
  v_max3_f32 v110, v110, |v75|, |v76|
  v_max3_f32 v86, v86, |v41|, |v42|
  v_max3_f32 v94, v94, |v53|, |v54|
  v_max3_f32 v102, v102, |v65|, |v66|
  v_max3_f32 v110, v110, |v77|, |v78|
  v_max3_f32 v86, v86, |v43|, s47
  v_max3_f32 v94, v94, |v55|, s47
  v_max3_f32 v102, v102, |v67|, s47
  v_max3_f32 v110, v110, |v79|, s47
  v_rcp_f32 v192, v86
  v_rcp_f32 v194, v94
  v_rcp_f32 v196, v102
  v_rcp_f32 v198, v110
  s_mov_b64 exec, s[42:43]
  v_pk_mul_f32 v[144:145], v[32:33], v[192:193] op_sel_hi:[1,0]
  v_pk_mul_f32 v[146:147], v[34:35], v[192:193] op_sel_hi:[1,0]
  v_pk_mul_f32 v[148:149], v[36:37], v[192:193] op_sel_hi:[1,0]
  v_pk_mul_f32 v[150:151], v[38:39], v[192:193] op_sel_hi:[1,0]
  v_pk_mul_f32 v[152:153], v[40:41], v[192:193] op_sel_hi:[1,0]
  v_pk_mul_f32 v[154:155], v[42:43], v[192:193] op_sel_hi:[1,0]
  v_cvt_pknorm_i16_f32 v80, v144, v145
  v_cvt_pknorm_i16_f32 v81, v146, v147
  v_cvt_pknorm_i16_f32 v82, v148, v149
  v_cvt_pknorm_i16_f32 v83, v150, v151
  v_cvt_pknorm_i16_f32 v84, v152, v153
  v_cvt_pknorm_i16_f32 v85, v154, v155
  buffer_store_dwordx4 v[80:83], v2, s[32:35], 0 offen sc1
  v_add3_u32 v87, v80, v81, v254
  v_add3_u32 v87, v87, v82, v83
  v_add3_u32 v87, v87, v84, v85
  v_add_u32 v87, v87, v86
  buffer_store_dwordx4 v[84:87], v2, s[32:35], 0 offen offset:1024 sc1
  v_pk_mul_f32 v[156:157], v[44:45], v[194:195] op_sel_hi:[1,0]
  v_pk_mul_f32 v[158:159], v[46:47], v[194:195] op_sel_hi:[1,0]
  v_pk_mul_f32 v[160:161], v[48:49], v[194:195] op_sel_hi:[1,0]
  v_pk_mul_f32 v[162:163], v[50:51], v[194:195] op_sel_hi:[1,0]
  v_pk_mul_f32 v[164:165], v[52:53], v[194:195] op_sel_hi:[1,0]
  v_pk_mul_f32 v[166:167], v[54:55], v[194:195] op_sel_hi:[1,0]
  v_cvt_pknorm_i16_f32 v88, v156, v157
  v_cvt_pknorm_i16_f32 v89, v158, v159
  v_cvt_pknorm_i16_f32 v90, v160, v161
  v_cvt_pknorm_i16_f32 v91, v162, v163
  v_cvt_pknorm_i16_f32 v92, v164, v165
  v_cvt_pknorm_i16_f32 v93, v166, v167
  buffer_store_dwordx4 v[88:91], v2, s[32:35], 0 offen offset:256 sc1
  v_add3_u32 v95, v88, v89, v254
  v_add3_u32 v95, v95, v90, v91
  v_add3_u32 v95, v95, v92, v93
  v_add_u32 v95, v95, v94
  buffer_store_dwordx4 v[92:95], v2, s[32:35], 0 offen offset:1280 sc1
  s_and_b32 exec_lo, 0x1111, s42
  s_mov_b32 exec_hi, 0
  buffer_store_dword v254, v6, s[32:35], 0 offen sc1
  s_mov_b64 exec, -1
  s_mov_b64 exec, s[42:43]
  v_pk_mul_f32 v[168:169], v[56:57], v[196:197] op_sel_hi:[1,0]
  v_pk_mul_f32 v[170:171], v[58:59], v[196:197] op_sel_hi:[1,0]
  v_pk_mul_f32 v[172:173], v[60:61], v[196:197] op_sel_hi:[1,0]
  v_pk_mul_f32 v[174:175], v[62:63], v[196:197] op_sel_hi:[1,0]
  v_pk_mul_f32 v[176:177], v[64:65], v[196:197] op_sel_hi:[1,0]
  v_pk_mul_f32 v[178:179], v[66:67], v[196:197] op_sel_hi:[1,0]
  v_cvt_pknorm_i16_f32 v96, v168, v169
  v_cvt_pknorm_i16_f32 v97, v170, v171
  v_cvt_pknorm_i16_f32 v98, v172, v173
  v_cvt_pknorm_i16_f32 v99, v174, v175
  v_cvt_pknorm_i16_f32 v100, v176, v177
  v_cvt_pknorm_i16_f32 v101, v178, v179
  buffer_store_dwordx4 v[96:99], v2, s[32:35], 0 offen offset:512 sc1
  v_add3_u32 v103, v96, v97, v254
  v_add3_u32 v103, v103, v98, v99
  v_add3_u32 v103, v103, v100, v101
  v_add_u32 v103, v103, v102
  buffer_store_dwordx4 v[100:103], v2, s[32:35], 0 offen offset:1536 sc1
  v_pk_mul_f32 v[180:181], v[68:69], v[198:199] op_sel_hi:[1,0]
  v_pk_mul_f32 v[182:183], v[70:71], v[198:199] op_sel_hi:[1,0]
  v_pk_mul_f32 v[184:185], v[72:73], v[198:199] op_sel_hi:[1,0]
  v_pk_mul_f32 v[186:187], v[74:75], v[198:199] op_sel_hi:[1,0]
  v_pk_mul_f32 v[188:189], v[76:77], v[198:199] op_sel_hi:[1,0]
  v_pk_mul_f32 v[190:191], v[78:79], v[198:199] op_sel_hi:[1,0]
  v_cvt_pknorm_i16_f32 v104, v180, v181
  v_cvt_pknorm_i16_f32 v105, v182, v183
  v_cvt_pknorm_i16_f32 v106, v184, v185
  v_cvt_pknorm_i16_f32 v107, v186, v187
  v_cvt_pknorm_i16_f32 v108, v188, v189
  v_cvt_pknorm_i16_f32 v109, v190, v191
  buffer_store_dwordx4 v[104:107], v2, s[32:35], 0 offen offset:768 sc1
  v_add3_u32 v111, v104, v105, v254
  v_add3_u32 v111, v111, v106, v107
  v_add3_u32 v111, v111, v108, v109
  v_add_u32 v111, v111, v110
  buffer_store_dwordx4 v[108:111], v2, s[32:35], 0 offen offset:1792 sc1
  s_mov_b64 exec, -1
  s_mov_b32 s49, 7
  s_mov_b32 s55, 32768
  s_mov_b64 exec, 7
  buffer_load_dword v152, v7, s[32:35], s53 offen sc1
  s_mov_b64 exec, -1
  s_not_b64 exec, s[42:43]
  ds_write_b128 v3, v[32:35] offset:0
  ds_write_b128 v3, v[36:39] offset:16
  ds_write_b128 v3, v[40:43] offset:32
  ds_write_b128 v3, v[44:47] offset:192
  ds_write_b128 v3, v[48:51] offset:208
  ds_write_b128 v3, v[52:55] offset:224
  ds_write_b128 v3, v[56:59] offset:384
  ds_write_b128 v3, v[60:63] offset:400
  ds_write_b128 v3, v[64:67] offset:416
  ds_write_b128 v3, v[68:71] offset:576
  ds_write_b128 v3, v[72:75] offset:592
  ds_write_b128 v3, v[76:79] offset:608
  s_mov_b64 exec, -1
  s_waitcnt lgkmcnt(0)
  ds_read_b128 v[160:163], v5 offset:0
  ds_read_b128 v[164:167], v5 offset:16
  ds_read_b128 v[168:171], v5 offset:32
  s_waitcnt lgkmcnt(0)
  s_mov_b64 exec, 7
  buffer_load_dword v153, v7, s[32:35], s53 offen sc1
L_pp:
  s_waitcnt vmcnt(1)
  v_cmp_ne_u32 vcc, s58, v152
  s_cbranch_vccz L_ppd
  buffer_load_dword v152, v7, s[32:35], s53 offen sc1
  s_waitcnt vmcnt(1)
  v_cmp_ne_u32 vcc, s58, v153
  s_cbranch_vccz L_ppd
  buffer_load_dword v153, v7, s[32:35], s53 offen sc1
  s_sub_u32 s55, s55, 1
  s_cmp_gt_i32 s55, 0
  s_cbranch_scc1 L_pp
L_ppd:
  s_mov_b64 exec, -1
  s_add_u32 s45, s44, 0
  buffer_load_dwordx4 v[112:115], v1, s[32:35], s45 offen sc1
  buffer_load_dwordx4 v[116:119], v1, s[32:35], s45 offen offset:1024 sc1
  s_add_u32 s45, s44, 2048
  buffer_load_dwordx4 v[120:123], v1, s[32:35], s45 offen sc1
  buffer_load_dwordx4 v[124:127], v1, s[32:35], s45 offen offset:1024 sc1
  s_add_u32 s45, s44, 4096
  buffer_load_dwordx4 v[128:131], v1, s[32:35], s45 offen sc1
  buffer_load_dwordx4 v[132:135], v1, s[32:35], s45 offen offset:1024 sc1
  s_waitcnt vmcnt(4)
  v_add3_u32 v150, v112, v113, v254
  v_add3_u32 v150, v150, v114, v115
  v_add3_u32 v150, v150, v116, v117
  v_add_u32 v150, v150, v118
  v_cmp_ne_u32 vcc, v150, v119
  s_cbranch_vccnz L_c1_0
  s_bitset0_b32 s49, 0
  v_mul_f32 v144, 0x38000100, v118
  v_cvt_f32_i32_sdwa v176, sext(v112) dst_sel:DWORD dst_unused:UNUSED_PAD src0_sel:WORD_0
  v_cvt_f32_i32_sdwa v177, sext(v112) dst_sel:DWORD dst_unused:UNUSED_PAD src0_sel:WORD_1
  v_cvt_f32_i32_sdwa v178, sext(v113) dst_sel:DWORD dst_unused:UNUSED_PAD src0_sel:WORD_0
  v_cvt_f32_i32_sdwa v179, sext(v113) dst_sel:DWORD dst_unused:UNUSED_PAD src0_sel:WORD_1
  v_cvt_f32_i32_sdwa v180, sext(v114) dst_sel:DWORD dst_unused:UNUSED_PAD src0_sel:WORD_0
  v_cvt_f32_i32_sdwa v181, sext(v114) dst_sel:DWORD dst_unused:UNUSED_PAD src0_sel:WORD_1
  v_cvt_f32_i32_sdwa v182, sext(v115) dst_sel:DWORD dst_unused:UNUSED_PAD src0_sel:WORD_0
  v_cvt_f32_i32_sdwa v183, sext(v115) dst_sel:DWORD dst_unused:UNUSED_PAD src0_sel:WORD_1
  v_cvt_f32_i32_sdwa v184, sext(v116) dst_sel:DWORD dst_unused:UNUSED_PAD src0_sel:WORD_0
  v_cvt_f32_i32_sdwa v185, sext(v116) dst_sel:DWORD dst_unused:UNUSED_PAD src0_sel:WORD_1
  v_cvt_f32_i32_sdwa v186, sext(v117) dst_sel:DWORD dst_unused:UNUSED_PAD src0_sel:WORD_0
  v_cvt_f32_i32_sdwa v187, sext(v117) dst_sel:DWORD dst_unused:UNUSED_PAD src0_sel:WORD_1
L_c1_0:
  s_waitcnt vmcnt(2)
  v_add3_u32 v150, v120, v121, v254
  v_add3_u32 v150, v150, v122, v123
  v_add3_u32 v150, v150, v124, v125
  v_add_u32 v150, v150, v126
  v_cmp_ne_u32 vcc, v150, v127
  s_cbranch_vccnz L_c1_1
  s_bitset0_b32 s49, 1
  v_mul_f32 v146, 0x38000100, v126
  v_cvt_f32_i32_sdwa v188, sext(v120) dst_sel:DWORD dst_unused:UNUSED_PAD src0_sel:WORD_0
  v_cvt_f32_i32_sdwa v189, sext(v120) dst_sel:DWORD dst_unused:UNUSED_PAD src0_sel:WORD_1
  v_cvt_f32_i32_sdwa v190, sext(v121) dst_sel:DWORD dst_unused:UNUSED_PAD src0_sel:WORD_0
  v_cvt_f32_i32_sdwa v191, sext(v121) dst_sel:DWORD dst_unused:UNUSED_PAD src0_sel:WORD_1
  v_cvt_f32_i32_sdwa v192, sext(v122) dst_sel:DWORD dst_unused:UNUSED_PAD src0_sel:WORD_0
  v_cvt_f32_i32_sdwa v193, sext(v122) dst_sel:DWORD dst_unused:UNUSED_PAD src0_sel:WORD_1
  v_cvt_f32_i32_sdwa v194, sext(v123) dst_sel:DWORD dst_unused:UNUSED_PAD src0_sel:WORD_0
  v_cvt_f32_i32_sdwa v195, sext(v123) dst_sel:DWORD dst_unused:UNUSED_PAD src0_sel:WORD_1
  v_cvt_f32_i32_sdwa v196, sext(v124) dst_sel:DWORD dst_unused:UNUSED_PAD src0_sel:WORD_0
  v_cvt_f32_i32_sdwa v197, sext(v124) dst_sel:DWORD dst_unused:UNUSED_PAD src0_sel:WORD_1
  v_cvt_f32_i32_sdwa v198, sext(v125) dst_sel:DWORD dst_unused:UNUSED_PAD src0_sel:WORD_0
  v_cvt_f32_i32_sdwa v199, sext(v125) dst_sel:DWORD dst_unused:UNUSED_PAD src0_sel:WORD_1
L_c1_1:
  s_waitcnt vmcnt(0)
  v_add3_u32 v150, v128, v129, v254
  v_add3_u32 v150, v150, v130, v131
  v_add3_u32 v150, v150, v132, v133
  v_add_u32 v150, v150, v134
  v_cmp_ne_u32 vcc, v150, v135
  s_cbranch_vccnz L_c1_2
  s_bitset0_b32 s49, 2
  v_mul_f32 v148, 0x38000100, v134
  v_cvt_f32_i32_sdwa v200, sext(v128) dst_sel:DWORD dst_unused:UNUSED_PAD src0_sel:WORD_0
  v_cvt_f32_i32_sdwa v201, sext(v128) dst_sel:DWORD dst_unused:UNUSED_PAD src0_sel:WORD_1
  v_cvt_f32_i32_sdwa v202, sext(v129) dst_sel:DWORD dst_unused:UNUSED_PAD src0_sel:WORD_0
  v_cvt_f32_i32_sdwa v203, sext(v129) dst_sel:DWORD dst_unused:UNUSED_PAD src0_sel:WORD_1
  v_cvt_f32_i32_sdwa v204, sext(v130) dst_sel:DWORD dst_unused:UNUSED_PAD src0_sel:WORD_0
  v_cvt_f32_i32_sdwa v205, sext(v130) dst_sel:DWORD dst_unused:UNUSED_PAD src0_sel:WORD_1
  v_cvt_f32_i32_sdwa v206, sext(v131) dst_sel:DWORD dst_unused:UNUSED_PAD src0_sel:WORD_0
  v_cvt_f32_i32_sdwa v207, sext(v131) dst_sel:DWORD dst_unused:UNUSED_PAD src0_sel:WORD_1
  v_cvt_f32_i32_sdwa v208, sext(v132) dst_sel:DWORD dst_unused:UNUSED_PAD src0_sel:WORD_0
  v_cvt_f32_i32_sdwa v209, sext(v132) dst_sel:DWORD dst_unused:UNUSED_PAD src0_sel:WORD_1
  v_cvt_f32_i32_sdwa v210, sext(v133) dst_sel:DWORD dst_unused:UNUSED_PAD src0_sel:WORD_0
  v_cvt_f32_i32_sdwa v211, sext(v133) dst_sel:DWORD dst_unused:UNUSED_PAD src0_sel:WORD_1
L_c1_2:
L_pld:
  s_cmp_eq_u32 s49, 0
  s_cbranch_scc1 L_pok
  s_sub_u32 s55, s55, 1
  s_cmp_gt_i32 s55, 0
  s_cbranch_scc0 L_pok
  s_bitcmp1_b32 s49, 0
  s_cbranch_scc0 L_l2_0
  s_add_u32 s45, s44, 0
  buffer_load_dwordx4 v[112:115], v1, s[32:35], s45 offen sc1
  buffer_load_dwordx4 v[116:119], v1, s[32:35], s45 offen offset:1024 sc1
L_l2_0:
  s_bitcmp1_b32 s49, 1
  s_cbranch_scc0 L_l2_1
  s_add_u32 s45, s44, 2048
  buffer_load_dwordx4 v[120:123], v1, s[32:35], s45 offen sc1
  buffer_load_dwordx4 v[124:127], v1, s[32:35], s45 offen offset:1024 sc1
L_l2_1:
  s_bitcmp1_b32 s49, 2
  s_cbranch_scc0 L_l2_2
  s_add_u32 s45, s44, 4096
  buffer_load_dwordx4 v[128:131], v1, s[32:35], s45 offen sc1
  buffer_load_dwordx4 v[132:135], v1, s[32:35], s45 offen offset:1024 sc1
L_l2_2:
  s_waitcnt vmcnt(0)
  s_bitcmp1_b32 s49, 0
  s_cbranch_scc0 L_c2_0
  v_add3_u32 v150, v112, v113, v254
  v_add3_u32 v150, v150, v114, v115
  v_add3_u32 v150, v150, v116, v117
  v_add_u32 v150, v150, v118
  v_cmp_ne_u32 vcc, v150, v119
  s_cbranch_vccnz L_c2_0
  s_bitset0_b32 s49, 0
  v_mul_f32 v144, 0x38000100, v118
  v_cvt_f32_i32_sdwa v176, sext(v112) dst_sel:DWORD dst_unused:UNUSED_PAD src0_sel:WORD_0
  v_cvt_f32_i32_sdwa v177, sext(v112) dst_sel:DWORD dst_unused:UNUSED_PAD src0_sel:WORD_1
  v_cvt_f32_i32_sdwa v178, sext(v113) dst_sel:DWORD dst_unused:UNUSED_PAD src0_sel:WORD_0
  v_cvt_f32_i32_sdwa v179, sext(v113) dst_sel:DWORD dst_unused:UNUSED_PAD src0_sel:WORD_1
  v_cvt_f32_i32_sdwa v180, sext(v114) dst_sel:DWORD dst_unused:UNUSED_PAD src0_sel:WORD_0
  v_cvt_f32_i32_sdwa v181, sext(v114) dst_sel:DWORD dst_unused:UNUSED_PAD src0_sel:WORD_1
  v_cvt_f32_i32_sdwa v182, sext(v115) dst_sel:DWORD dst_unused:UNUSED_PAD src0_sel:WORD_0
  v_cvt_f32_i32_sdwa v183, sext(v115) dst_sel:DWORD dst_unused:UNUSED_PAD src0_sel:WORD_1
  v_cvt_f32_i32_sdwa v184, sext(v116) dst_sel:DWORD dst_unused:UNUSED_PAD src0_sel:WORD_0
  v_cvt_f32_i32_sdwa v185, sext(v116) dst_sel:DWORD dst_unused:UNUSED_PAD src0_sel:WORD_1
  v_cvt_f32_i32_sdwa v186, sext(v117) dst_sel:DWORD dst_unused:UNUSED_PAD src0_sel:WORD_0
  v_cvt_f32_i32_sdwa v187, sext(v117) dst_sel:DWORD dst_unused:UNUSED_PAD src0_sel:WORD_1
L_c2_0:
  s_bitcmp1_b32 s49, 1
  s_cbranch_scc0 L_c2_1
  v_add3_u32 v150, v120, v121, v254
  v_add3_u32 v150, v150, v122, v123
  v_add3_u32 v150, v150, v124, v125
  v_add_u32 v150, v150, v126
  v_cmp_ne_u32 vcc, v150, v127
  s_cbranch_vccnz L_c2_1
  s_bitset0_b32 s49, 1
  v_mul_f32 v146, 0x38000100, v126
  v_cvt_f32_i32_sdwa v188, sext(v120) dst_sel:DWORD dst_unused:UNUSED_PAD src0_sel:WORD_0
  v_cvt_f32_i32_sdwa v189, sext(v120) dst_sel:DWORD dst_unused:UNUSED_PAD src0_sel:WORD_1
  v_cvt_f32_i32_sdwa v190, sext(v121) dst_sel:DWORD dst_unused:UNUSED_PAD src0_sel:WORD_0
  v_cvt_f32_i32_sdwa v191, sext(v121) dst_sel:DWORD dst_unused:UNUSED_PAD src0_sel:WORD_1
  v_cvt_f32_i32_sdwa v192, sext(v122) dst_sel:DWORD dst_unused:UNUSED_PAD src0_sel:WORD_0
  v_cvt_f32_i32_sdwa v193, sext(v122) dst_sel:DWORD dst_unused:UNUSED_PAD src0_sel:WORD_1
  v_cvt_f32_i32_sdwa v194, sext(v123) dst_sel:DWORD dst_unused:UNUSED_PAD src0_sel:WORD_0
  v_cvt_f32_i32_sdwa v195, sext(v123) dst_sel:DWORD dst_unused:UNUSED_PAD src0_sel:WORD_1
  v_cvt_f32_i32_sdwa v196, sext(v124) dst_sel:DWORD dst_unused:UNUSED_PAD src0_sel:WORD_0
  v_cvt_f32_i32_sdwa v197, sext(v124) dst_sel:DWORD dst_unused:UNUSED_PAD src0_sel:WORD_1
  v_cvt_f32_i32_sdwa v198, sext(v125) dst_sel:DWORD dst_unused:UNUSED_PAD src0_sel:WORD_0
  v_cvt_f32_i32_sdwa v199, sext(v125) dst_sel:DWORD dst_unused:UNUSED_PAD src0_sel:WORD_1
L_c2_1:
  s_bitcmp1_b32 s49, 2
  s_cbranch_scc0 L_c2_2
  v_add3_u32 v150, v128, v129, v254
  v_add3_u32 v150, v150, v130, v131
  v_add3_u32 v150, v150, v132, v133
  v_add_u32 v150, v150, v134
  v_cmp_ne_u32 vcc, v150, v135
  s_cbranch_vccnz L_c2_2
  s_bitset0_b32 s49, 2
  v_mul_f32 v148, 0x38000100, v134
  v_cvt_f32_i32_sdwa v200, sext(v128) dst_sel:DWORD dst_unused:UNUSED_PAD src0_sel:WORD_0
  v_cvt_f32_i32_sdwa v201, sext(v128) dst_sel:DWORD dst_unused:UNUSED_PAD src0_sel:WORD_1
  v_cvt_f32_i32_sdwa v202, sext(v129) dst_sel:DWORD dst_unused:UNUSED_PAD src0_sel:WORD_0
  v_cvt_f32_i32_sdwa v203, sext(v129) dst_sel:DWORD dst_unused:UNUSED_PAD src0_sel:WORD_1
  v_cvt_f32_i32_sdwa v204, sext(v130) dst_sel:DWORD dst_unused:UNUSED_PAD src0_sel:WORD_0
  v_cvt_f32_i32_sdwa v205, sext(v130) dst_sel:DWORD dst_unused:UNUSED_PAD src0_sel:WORD_1
  v_cvt_f32_i32_sdwa v206, sext(v131) dst_sel:DWORD dst_unused:UNUSED_PAD src0_sel:WORD_0
  v_cvt_f32_i32_sdwa v207, sext(v131) dst_sel:DWORD dst_unused:UNUSED_PAD src0_sel:WORD_1
  v_cvt_f32_i32_sdwa v208, sext(v132) dst_sel:DWORD dst_unused:UNUSED_PAD src0_sel:WORD_0
  v_cvt_f32_i32_sdwa v209, sext(v132) dst_sel:DWORD dst_unused:UNUSED_PAD src0_sel:WORD_1
  v_cvt_f32_i32_sdwa v210, sext(v133) dst_sel:DWORD dst_unused:UNUSED_PAD src0_sel:WORD_0
  v_cvt_f32_i32_sdwa v211, sext(v133) dst_sel:DWORD dst_unused:UNUSED_PAD src0_sel:WORD_1
L_c2_2:
  s_branch L_pld
L_pok:
  s_waitcnt lgkmcnt(0)
  v_pk_fma_f32 v[160:161], v[176:177], v[144:145], v[160:161] op_sel_hi:[1,0,1]
  v_pk_fma_f32 v[162:163], v[178:179], v[144:145], v[162:163] op_sel_hi:[1,0,1]
  v_pk_fma_f32 v[164:165], v[180:181], v[144:145], v[164:165] op_sel_hi:[1,0,1]
  v_pk_fma_f32 v[166:167], v[182:183], v[144:145], v[166:167] op_sel_hi:[1,0,1]
  v_pk_fma_f32 v[168:169], v[184:185], v[144:145], v[168:169] op_sel_hi:[1,0,1]
  v_pk_fma_f32 v[170:171], v[186:187], v[144:145], v[170:171] op_sel_hi:[1,0,1]
  v_pk_fma_f32 v[160:161], v[188:189], v[146:147], v[160:161] op_sel_hi:[1,0,1]
  v_pk_fma_f32 v[162:163], v[190:191], v[146:147], v[162:163] op_sel_hi:[1,0,1]
  v_pk_fma_f32 v[164:165], v[192:193], v[146:147], v[164:165] op_sel_hi:[1,0,1]
  v_pk_fma_f32 v[166:167], v[194:195], v[146:147], v[166:167] op_sel_hi:[1,0,1]
  v_pk_fma_f32 v[168:169], v[196:197], v[146:147], v[168:169] op_sel_hi:[1,0,1]
  v_pk_fma_f32 v[170:171], v[198:199], v[146:147], v[170:171] op_sel_hi:[1,0,1]
  v_pk_fma_f32 v[160:161], v[200:201], v[148:149], v[160:161] op_sel_hi:[1,0,1]
  v_pk_fma_f32 v[162:163], v[202:203], v[148:149], v[162:163] op_sel_hi:[1,0,1]
  v_pk_fma_f32 v[164:165], v[204:205], v[148:149], v[164:165] op_sel_hi:[1,0,1]
  v_pk_fma_f32 v[166:167], v[206:207], v[148:149], v[166:167] op_sel_hi:[1,0,1]
  v_pk_fma_f32 v[168:169], v[208:209], v[148:149], v[168:169] op_sel_hi:[1,0,1]
  v_pk_fma_f32 v[170:171], v[210:211], v[148:149], v[170:171] op_sel_hi:[1,0,1]
  v_cvt_pk_bf16_f32 v160, v160, v161
  v_cvt_pk_bf16_f32 v161, v162, v163
  buffer_store_dwordx2 v[160:161], v4, s[88:91], s54 offen sc1
  s_add_u32 s54, s54, 32768
  v_cvt_pk_bf16_f32 v164, v164, v165
  v_cvt_pk_bf16_f32 v165, v166, v167
  buffer_store_dwordx2 v[164:165], v4, s[88:91], s54 offen sc1
  s_add_u32 s54, s54, 32768
  v_cvt_pk_bf16_f32 v168, v168, v169
  v_cvt_pk_bf16_f32 v169, v170, v171
  buffer_store_dwordx2 v[168:169], v4, s[88:91], s54 offen sc1
  s_endpgm
L_ld45:
  s_waitcnt lgkmcnt(0)
  s_mov_b32 s52, 1
  s_branch L_ldbx
L_pref:
  v_subrev_u32 v16, 65536, v8
  v_subrev_u32 v17, 65536, v9
  v_subrev_u32 v18, 65536, v10
  v_subrev_u32 v19, 65536, v11
  s_add_u32 s45, s40, 0
  s_and_b32 s45, s45, 3
  s_and_b32 s46, s40, 4
  s_or_b32 s45, s45, s46
  s_lshl_b32 s45, s45, 1
  s_lshl_b32 s42, s45, 17
  s_add_u32 m0, s44, 0
  s_nop 0
  buffer_load_dwordx4 v8, s[84:87], s42 offen lds
  buffer_load_dwordx4 v9, s[84:87], s42 offen offset:1024 lds
  buffer_load_dwordx4 v10, s[84:87], s42 offen offset:2048 lds
  buffer_load_dwordx4 v11, s[84:87], s42 offen offset:3072 lds
  s_sub_u32 s44, s44, 8192
  s_add_u32 m0, s44, 0
  s_nop 0
  buffer_load_dwordx4 v16, s[84:87], s42 offen lds
  buffer_load_dwordx4 v17, s[84:87], s42 offen offset:1024 lds
  buffer_load_dwordx4 v18, s[84:87], s42 offen offset:2048 lds
  buffer_load_dwordx4 v19, s[84:87], s42 offen offset:3072 lds
  s_add_u32 s44, s44, 8192
  s_add_u32 s45, s40, 0
  s_and_b32 s45, s45, 3
  s_and_b32 s46, s40, 4
  s_or_b32 s45, s45, s46
  s_lshl_b32 s45, s45, 1
  s_add_u32 s45, s45, 1
  s_lshl_b32 s42, s45, 17
  s_add_u32 m0, s44, 28672
  s_nop 0
  buffer_load_dwordx4 v8, s[84:87], s42 offen lds
  buffer_load_dwordx4 v9, s[84:87], s42 offen offset:1024 lds
  buffer_load_dwordx4 v10, s[84:87], s42 offen offset:2048 lds
  buffer_load_dwordx4 v11, s[84:87], s42 offen offset:3072 lds
  s_sub_u32 s44, s44, 8192
  s_add_u32 m0, s44, 28672
  s_nop 0
  buffer_load_dwordx4 v16, s[84:87], s42 offen lds
  buffer_load_dwordx4 v17, s[84:87], s42 offen offset:1024 lds
  buffer_load_dwordx4 v18, s[84:87], s42 offen offset:2048 lds
  buffer_load_dwordx4 v19, s[84:87], s42 offen offset:3072 lds
  s_add_u32 s44, s44, 8192
  s_add_u32 s45, s40, 1
  s_and_b32 s45, s45, 3
  s_and_b32 s46, s40, 4
  s_or_b32 s45, s45, s46
  s_lshl_b32 s45, s45, 1
  s_lshl_b32 s42, s45, 17
  s_add_u32 m0, s44, 57344
  s_nop 0
  buffer_load_dwordx4 v8, s[84:87], s42 offen lds
  buffer_load_dwordx4 v9, s[84:87], s42 offen offset:1024 lds
  buffer_load_dwordx4 v10, s[84:87], s42 offen offset:2048 lds
  buffer_load_dwordx4 v11, s[84:87], s42 offen offset:3072 lds
  s_sub_u32 s44, s44, 8192
  s_add_u32 m0, s44, 57344
  s_nop 0
  buffer_load_dwordx4 v16, s[84:87], s42 offen lds
  buffer_load_dwordx4 v17, s[84:87], s42 offen offset:1024 lds
  buffer_load_dwordx4 v18, s[84:87], s42 offen offset:2048 lds
  buffer_load_dwordx4 v19, s[84:87], s42 offen offset:3072 lds
  s_add_u32 s44, s44, 8192
  s_add_u32 s45, s40, 1
  s_and_b32 s45, s45, 3
  s_and_b32 s46, s40, 4
  s_or_b32 s45, s45, s46
  s_lshl_b32 s45, s45, 1
  s_add_u32 s45, s45, 1
  s_lshl_b32 s42, s45, 17
  s_add_u32 m0, s44, 86016
  s_nop 0
  buffer_load_dwordx4 v8, s[84:87], s42 offen lds
  buffer_load_dwordx4 v9, s[84:87], s42 offen offset:1024 lds
  buffer_load_dwordx4 v10, s[84:87], s42 offen offset:2048 lds
  buffer_load_dwordx4 v11, s[84:87], s42 offen offset:3072 lds
  s_sub_u32 s44, s44, 8192
  s_add_u32 m0, s44, 86016
  s_nop 0
  buffer_load_dwordx4 v16, s[84:87], s42 offen lds
  buffer_load_dwordx4 v17, s[84:87], s42 offen offset:1024 lds
  buffer_load_dwordx4 v18, s[84:87], s42 offen offset:2048 lds
  buffer_load_dwordx4 v19, s[84:87], s42 offen offset:3072 lds
  s_add_u32 s44, s44, 8192
  s_waitcnt vmcnt(0)
  s_mov_b32 s52, 0
L_ldbx:
  s_sub_u32 s57, s36, 4
  v_lshlrev_b32 v1, 4, v0
  s_mul_i32 s45, s57, 3072
  v_add_u32 v1, s45, v1
  s_lshl_b32 s45, s38, 5
  s_lshl_b32 s46, s39, 3
  s_add_u32 s45, s45, s46
  s_mul_i32 s49, s45, 24576
  v_and_b32 v2, 7, v0
  v_lshlrev_b32 v2, 8, v2
  s_lshl_b32 s45, s39, 3
  s_add_u32 s45, s45, s38
  s_lshl_b32 s45, s45, 11
  s_add_u32 s53, s45, 20971520
  s_mov_b64 s[96:97], 0
  s_barrier
  s_cmp_eq_u32 s52, 1
  s_cbranch_scc0 L_nofl
L_nofl:
  s_add_u32 s45, s40, 2
  s_and_b32 s45, s45, 3
  s_and_b32 s46, s40, 4
  s_or_b32 s45, s45, s46
  s_lshl_b32 s45, s45, 1
  s_lshl_b32 s42, s45, 17
  s_mul_i32 s41, s45, 12288
  s_add_u32 s41, s41, s49
  s_add_u32 m0, s44, 102400
  s_nop 0
  buffer_load_dwordx4 v8, s[84:87], s42 offen lds
  buffer_load_dwordx4 v9, s[84:87], s42 offen offset:1024 lds
  buffer_load_dwordx4 v10, s[84:87], s42 offen offset:2048 lds
  buffer_load_dwordx4 v11, s[84:87], s42 offen offset:3072 lds
  s_add_u32 s45, s40, 2
  s_and_b32 s45, s45, 3
  s_and_b32 s46, s40, 4
  s_or_b32 s45, s45, s46
  s_lshl_b32 s45, s45, 1
  s_add_u32 s45, s45, 1
  s_lshl_b32 s42, s45, 17
  s_mul_i32 s41, s45, 12288
  s_add_u32 s41, s41, s49
  s_add_u32 m0, s44, 118784
  s_nop 0
  buffer_load_dwordx4 v8, s[84:87], s42 offen lds
  buffer_load_dwordx4 v9, s[84:87], s42 offen offset:1024 lds
  buffer_load_dwordx4 v10, s[84:87], s42 offen offset:2048 lds
  buffer_load_dwordx4 v11, s[84:87], s42 offen offset:3072 lds
  s_add_u32 s45, s40, 3
  s_and_b32 s45, s45, 3
  s_and_b32 s46, s40, 4
  s_or_b32 s45, s45, s46
  s_lshl_b32 s45, s45, 1
  s_lshl_b32 s42, s45, 17
  s_mul_i32 s41, s45, 12288
  s_add_u32 s41, s41, s49
  s_add_u32 m0, s44, 135168
  s_nop 0
  buffer_load_dwordx4 v8, s[84:87], s42 offen lds
  buffer_load_dwordx4 v9, s[84:87], s42 offen offset:1024 lds
  buffer_load_dwordx4 v10, s[84:87], s42 offen offset:2048 lds
  buffer_load_dwordx4 v11, s[84:87], s42 offen offset:3072 lds
  s_barrier
  s_add_u32 s45, s40, 0
  s_and_b32 s45, s45, 3
  s_and_b32 s46, s40, 4
  s_xor_b32 s46, s46, 4
  s_or_b32 s45, s45, s46
  s_lshl_b32 s45, s45, 1
  s_lshl_b32 s42, s45, 17
  s_mul_i32 s41, s45, 12288
  s_add_u32 s41, s41, s49
  s_add_u32 m0, s44, 0
  s_nop 0
  buffer_load_dwordx4 v8, s[84:87], s42 offen lds
  buffer_load_dwordx4 v9, s[84:87], s42 offen offset:1024 lds
  buffer_load_dwordx4 v10, s[84:87], s42 offen offset:2048 lds
  buffer_load_dwordx4 v11, s[84:87], s42 offen offset:3072 lds
  s_add_u32 s54, s40, 1
  s_and_b32 s54, s54, 3
  s_and_b32 s46, s40, 4
  s_or_b32 s54, s54, s46
  s_mov_b32 s55, 32768
L_g1:
  s_bitcmp1_b32 s96, s54
  s_cbranch_scc1 L_gd1
  s_sub_u32 s55, s55, 1
  s_cmp_gt_i32 s55, 0
  s_cbranch_scc0 L_gd1
  buffer_load_dwordx2 v[12:13], v2, s[32:35], s53 offen sc1
  s_waitcnt vmcnt(0)
  v_cmp_eq_u64 s[96:97], s[58:59], v[12:13]
  s_branch L_g1
L_gd1:
  s_add_u32 s45, s40, 1
  s_and_b32 s45, s45, 3
  s_and_b32 s46, s40, 4
  s_or_b32 s45, s45, s46
  s_lshl_b32 s45, s45, 1
  s_lshl_b32 s42, s45, 17
  s_mul_i32 s41, s45, 12288
  s_add_u32 s41, s41, s49
  s_add_u32 m0, s43, 57344
  s_nop 0
  buffer_load_dwordx4 v1, s[32:35], s41 offen sc1 lds
  buffer_load_dwordx4 v1, s[32:35], s41 offen offset:1024 sc1 lds
  buffer_load_dwordx4 v1, s[32:35], s41 offen offset:2048 sc1 lds
  s_add_u32 s45, s40, 1
  s_and_b32 s45, s45, 3
  s_and_b32 s46, s40, 4
  s_or_b32 s45, s45, s46
  s_lshl_b32 s45, s45, 1
  s_add_u32 s45, s45, 1
  s_lshl_b32 s42, s45, 17
  s_mul_i32 s41, s45, 12288
  s_add_u32 s41, s41, s49
  s_add_u32 m0, s43, 86016
  s_nop 0
  buffer_load_dwordx4 v1, s[32:35], s41 offen sc1 lds
  buffer_load_dwordx4 v1, s[32:35], s41 offen offset:1024 sc1 lds
  buffer_load_dwordx4 v1, s[32:35], s41 offen offset:2048 sc1 lds
  s_waitcnt vmcnt(3)
  s_barrier
  s_add_u32 s54, s40, 2
  s_and_b32 s54, s54, 3
  s_and_b32 s46, s40, 4
  s_or_b32 s54, s54, s46
  s_mov_b32 s55, 32768
L_g2:
  s_bitcmp1_b32 s96, s54
  s_cbranch_scc1 L_gd2
  s_sub_u32 s55, s55, 1
  s_cmp_gt_i32 s55, 0
  s_cbranch_scc0 L_gd2
  buffer_load_dwordx2 v[12:13], v2, s[32:35], s53 offen sc1
  s_waitcnt vmcnt(0)
  v_cmp_eq_u64 s[96:97], s[58:59], v[12:13]
  s_branch L_g2
L_gd2:
  s_add_u32 s45, s40, 2
  s_and_b32 s45, s45, 3
  s_and_b32 s46, s40, 4
  s_or_b32 s45, s45, s46
  s_lshl_b32 s45, s45, 1
  s_lshl_b32 s42, s45, 17
  s_mul_i32 s41, s45, 12288
  s_add_u32 s41, s41, s49
  s_add_u32 m0, s43, 0
  s_nop 0
  buffer_load_dwordx4 v1, s[32:35], s41 offen sc1 lds
  buffer_load_dwordx4 v1, s[32:35], s41 offen offset:1024 sc1 lds
  buffer_load_dwordx4 v1, s[32:35], s41 offen offset:2048 sc1 lds
  s_add_u32 s45, s40, 2
  s_and_b32 s45, s45, 3
  s_and_b32 s46, s40, 4
  s_or_b32 s45, s45, s46
  s_lshl_b32 s45, s45, 1
  s_add_u32 s45, s45, 1
  s_lshl_b32 s42, s45, 17
  s_mul_i32 s41, s45, 12288
  s_add_u32 s41, s41, s49
  s_add_u32 m0, s43, 28672
  s_nop 0
  buffer_load_dwordx4 v1, s[32:35], s41 offen sc1 lds
  buffer_load_dwordx4 v1, s[32:35], s41 offen offset:1024 sc1 lds
  buffer_load_dwordx4 v1, s[32:35], s41 offen offset:2048 sc1 lds
  s_waitcnt vmcnt(6)
  s_barrier
  s_add_u32 s54, s40, 3
  s_and_b32 s54, s54, 3
  s_and_b32 s46, s40, 4
  s_or_b32 s54, s54, s46
  s_mov_b32 s55, 32768
L_g3:
  s_bitcmp1_b32 s96, s54
  s_cbranch_scc1 L_gd3
  s_sub_u32 s55, s55, 1
  s_cmp_gt_i32 s55, 0
  s_cbranch_scc0 L_gd3
  buffer_load_dwordx2 v[12:13], v2, s[32:35], s53 offen sc1
  s_waitcnt vmcnt(0)
  v_cmp_eq_u64 s[96:97], s[58:59], v[12:13]
  s_branch L_g3
L_gd3:
  s_add_u32 s45, s40, 3
  s_and_b32 s45, s45, 3
  s_and_b32 s46, s40, 4
  s_or_b32 s45, s45, s46
  s_lshl_b32 s45, s45, 1
  s_lshl_b32 s42, s45, 17
  s_mul_i32 s41, s45, 12288
  s_add_u32 s41, s41, s49
  s_add_u32 m0, s43, 57344
  s_nop 0
  buffer_load_dwordx4 v1, s[32:35], s41 offen sc1 lds
  buffer_load_dwordx4 v1, s[32:35], s41 offen offset:1024 sc1 lds
  buffer_load_dwordx4 v1, s[32:35], s41 offen offset:2048 sc1 lds
  s_waitcnt vmcnt(6)
  s_barrier
  s_add_u32 s45, s40, 3
  s_and_b32 s45, s45, 3
  s_and_b32 s46, s40, 4
  s_or_b32 s45, s45, s46
  s_lshl_b32 s45, s45, 1
  s_add_u32 s45, s45, 1
  s_lshl_b32 s42, s45, 17
  s_mul_i32 s41, s45, 12288
  s_add_u32 s41, s41, s49
  s_add_u32 m0, s43, 86016
  s_nop 0
  buffer_load_dwordx4 v1, s[32:35], s41 offen sc1 lds
  buffer_load_dwordx4 v1, s[32:35], s41 offen offset:1024 sc1 lds
  buffer_load_dwordx4 v1, s[32:35], s41 offen offset:2048 sc1 lds
  s_add_u32 m0, s44, 86016
  s_nop 0
  buffer_load_dwordx4 v8, s[84:87], s42 offen lds
  buffer_load_dwordx4 v9, s[84:87], s42 offen offset:1024 lds
  buffer_load_dwordx4 v10, s[84:87], s42 offen offset:2048 lds
  buffer_load_dwordx4 v11, s[84:87], s42 offen offset:3072 lds
  s_waitcnt vmcnt(10)
  s_barrier
  s_add_u32 s54, s40, 0
  s_and_b32 s54, s54, 3
  s_and_b32 s46, s40, 4
  s_xor_b32 s46, s46, 4
  s_or_b32 s54, s54, s46
  s_mov_b32 s55, 32768
L_g4:
  s_bitcmp1_b32 s96, s54
  s_cbranch_scc1 L_gd4
  s_sub_u32 s55, s55, 1
  s_cmp_gt_i32 s55, 0
  s_cbranch_scc0 L_gd4
  buffer_load_dwordx2 v[12:13], v2, s[32:35], s53 offen sc1
  s_waitcnt vmcnt(0)
  v_cmp_eq_u64 s[96:97], s[58:59], v[12:13]
  s_branch L_g4
L_gd4:
  s_add_u32 s45, s40, 0
  s_and_b32 s45, s45, 3
  s_and_b32 s46, s40, 4
  s_xor_b32 s46, s46, 4
  s_or_b32 s45, s45, s46
  s_lshl_b32 s45, s45, 1
  s_lshl_b32 s42, s45, 17
  s_mul_i32 s41, s45, 12288
  s_add_u32 s41, s41, s49
  s_add_u32 m0, s43, 0
  s_nop 0
  buffer_load_dwordx4 v1, s[32:35], s41 offen sc1 lds
  buffer_load_dwordx4 v1, s[32:35], s41 offen offset:1024 sc1 lds
  buffer_load_dwordx4 v1, s[32:35], s41 offen offset:2048 sc1 lds
  s_waitcnt vmcnt(10)
  s_barrier
  s_add_u32 s45, s40, 0
  s_and_b32 s45, s45, 3
  s_and_b32 s46, s40, 4
  s_xor_b32 s46, s46, 4
  s_or_b32 s45, s45, s46
  s_lshl_b32 s45, s45, 1
  s_add_u32 s45, s45, 1
  s_lshl_b32 s42, s45, 17
  s_mul_i32 s41, s45, 12288
  s_add_u32 s41, s41, s49
  s_add_u32 m0, s43, 28672
  s_nop 0
  buffer_load_dwordx4 v1, s[32:35], s41 offen sc1 lds
  buffer_load_dwordx4 v1, s[32:35], s41 offen offset:1024 sc1 lds
  buffer_load_dwordx4 v1, s[32:35], s41 offen offset:2048 sc1 lds
  s_add_u32 m0, s44, 28672
  s_nop 0
  buffer_load_dwordx4 v8, s[84:87], s42 offen lds
  buffer_load_dwordx4 v9, s[84:87], s42 offen offset:1024 lds
  buffer_load_dwordx4 v10, s[84:87], s42 offen offset:2048 lds
  buffer_load_dwordx4 v11, s[84:87], s42 offen offset:3072 lds
  s_waitcnt vmcnt(10)
  s_barrier
  s_add_u32 s54, s40, 1
  s_and_b32 s54, s54, 3
  s_and_b32 s46, s40, 4
  s_xor_b32 s46, s46, 4
  s_or_b32 s54, s54, s46
  s_mov_b32 s55, 32768
L_g5:
  s_bitcmp1_b32 s96, s54
  s_cbranch_scc1 L_gd5
  s_sub_u32 s55, s55, 1
  s_cmp_gt_i32 s55, 0
  s_cbranch_scc0 L_gd5
  buffer_load_dwordx2 v[12:13], v2, s[32:35], s53 offen sc1
  s_waitcnt vmcnt(0)
  v_cmp_eq_u64 s[96:97], s[58:59], v[12:13]
  s_branch L_g5
L_gd5:
  s_add_u32 s45, s40, 1
  s_and_b32 s45, s45, 3
  s_and_b32 s46, s40, 4
  s_xor_b32 s46, s46, 4
  s_or_b32 s45, s45, s46
  s_lshl_b32 s45, s45, 1
  s_lshl_b32 s42, s45, 17
  s_mul_i32 s41, s45, 12288
  s_add_u32 s41, s41, s49
  s_add_u32 m0, s43, 57344
  s_nop 0
  buffer_load_dwordx4 v1, s[32:35], s41 offen sc1 lds
  buffer_load_dwordx4 v1, s[32:35], s41 offen offset:1024 sc1 lds
  buffer_load_dwordx4 v1, s[32:35], s41 offen offset:2048 sc1 lds
  s_add_u32 m0, s44, 57344
  s_nop 0
  buffer_load_dwordx4 v8, s[84:87], s42 offen lds
  buffer_load_dwordx4 v9, s[84:87], s42 offen offset:1024 lds
  buffer_load_dwordx4 v10, s[84:87], s42 offen offset:2048 lds
  buffer_load_dwordx4 v11, s[84:87], s42 offen offset:3072 lds
  s_waitcnt vmcnt(14)
  s_barrier
  s_add_u32 s45, s40, 1
  s_and_b32 s45, s45, 3
  s_and_b32 s46, s40, 4
  s_xor_b32 s46, s46, 4
  s_or_b32 s45, s45, s46
  s_lshl_b32 s45, s45, 1
  s_add_u32 s45, s45, 1
  s_lshl_b32 s42, s45, 17
  s_mul_i32 s41, s45, 12288
  s_add_u32 s41, s41, s49
  s_add_u32 m0, s43, 86016
  s_nop 0
  buffer_load_dwordx4 v1, s[32:35], s41 offen sc1 lds
  buffer_load_dwordx4 v1, s[32:35], s41 offen offset:1024 sc1 lds
  buffer_load_dwordx4 v1, s[32:35], s41 offen offset:2048 sc1 lds
  s_add_u32 m0, s44, 86016
  s_nop 0
  buffer_load_dwordx4 v8, s[84:87], s42 offen lds
  buffer_load_dwordx4 v9, s[84:87], s42 offen offset:1024 lds
  buffer_load_dwordx4 v10, s[84:87], s42 offen offset:2048 lds
  buffer_load_dwordx4 v11, s[84:87], s42 offen offset:3072 lds
  s_waitcnt vmcnt(14)
  s_barrier
  s_add_u32 s54, s40, 2
  s_and_b32 s54, s54, 3
  s_and_b32 s46, s40, 4
  s_xor_b32 s46, s46, 4
  s_or_b32 s54, s54, s46
  s_mov_b32 s55, 32768
L_g6:
  s_bitcmp1_b32 s96, s54
  s_cbranch_scc1 L_gd6
  s_sub_u32 s55, s55, 1
  s_cmp_gt_i32 s55, 0
  s_cbranch_scc0 L_gd6
  buffer_load_dwordx2 v[12:13], v2, s[32:35], s53 offen sc1
  s_waitcnt vmcnt(0)
  v_cmp_eq_u64 s[96:97], s[58:59], v[12:13]
  s_branch L_g6
L_gd6:
  s_add_u32 s45, s40, 2
  s_and_b32 s45, s45, 3
  s_and_b32 s46, s40, 4
  s_xor_b32 s46, s46, 4
  s_or_b32 s45, s45, s46
  s_lshl_b32 s45, s45, 1
  s_lshl_b32 s42, s45, 17
  s_mul_i32 s41, s45, 12288
  s_add_u32 s41, s41, s49
  s_add_u32 m0, s43, 0
  s_nop 0
  buffer_load_dwordx4 v1, s[32:35], s41 offen sc1 lds
  buffer_load_dwordx4 v1, s[32:35], s41 offen offset:1024 sc1 lds
  buffer_load_dwordx4 v1, s[32:35], s41 offen offset:2048 sc1 lds
  s_add_u32 m0, s44, 0
  s_nop 0
  buffer_load_dwordx4 v8, s[84:87], s42 offen lds
  buffer_load_dwordx4 v9, s[84:87], s42 offen offset:1024 lds
  buffer_load_dwordx4 v10, s[84:87], s42 offen offset:2048 lds
  buffer_load_dwordx4 v11, s[84:87], s42 offen offset:3072 lds
  s_waitcnt vmcnt(14)
  s_barrier
  s_add_u32 s45, s40, 2
  s_and_b32 s45, s45, 3
  s_and_b32 s46, s40, 4
  s_xor_b32 s46, s46, 4
  s_or_b32 s45, s45, s46
  s_lshl_b32 s45, s45, 1
  s_add_u32 s45, s45, 1
  s_lshl_b32 s42, s45, 17
  s_mul_i32 s41, s45, 12288
  s_add_u32 s41, s41, s49
  s_add_u32 m0, s43, 28672
  s_nop 0
  buffer_load_dwordx4 v1, s[32:35], s41 offen sc1 lds
  buffer_load_dwordx4 v1, s[32:35], s41 offen offset:1024 sc1 lds
  buffer_load_dwordx4 v1, s[32:35], s41 offen offset:2048 sc1 lds
  s_add_u32 m0, s44, 28672
  s_nop 0
  buffer_load_dwordx4 v8, s[84:87], s42 offen lds
  buffer_load_dwordx4 v9, s[84:87], s42 offen offset:1024 lds
  buffer_load_dwordx4 v10, s[84:87], s42 offen offset:2048 lds
  buffer_load_dwordx4 v11, s[84:87], s42 offen offset:3072 lds
  s_waitcnt vmcnt(14)
  s_barrier
  s_add_u32 s54, s40, 3
  s_and_b32 s54, s54, 3
  s_and_b32 s46, s40, 4
  s_xor_b32 s46, s46, 4
  s_or_b32 s54, s54, s46
  s_mov_b32 s55, 32768
L_g7:
  s_bitcmp1_b32 s96, s54
  s_cbranch_scc1 L_gd7
  s_sub_u32 s55, s55, 1
  s_cmp_gt_i32 s55, 0
  s_cbranch_scc0 L_gd7
  buffer_load_dwordx2 v[12:13], v2, s[32:35], s53 offen sc1
  s_waitcnt vmcnt(0)
  v_cmp_eq_u64 s[96:97], s[58:59], v[12:13]
  s_branch L_g7
L_gd7:
  s_add_u32 s45, s40, 3
  s_and_b32 s45, s45, 3
  s_and_b32 s46, s40, 4
  s_xor_b32 s46, s46, 4
  s_or_b32 s45, s45, s46
  s_lshl_b32 s45, s45, 1
  s_lshl_b32 s42, s45, 17
  s_mul_i32 s41, s45, 12288
  s_add_u32 s41, s41, s49
  s_add_u32 m0, s43, 57344
  s_nop 0
  buffer_load_dwordx4 v1, s[32:35], s41 offen sc1 lds
  buffer_load_dwordx4 v1, s[32:35], s41 offen offset:1024 sc1 lds
  buffer_load_dwordx4 v1, s[32:35], s41 offen offset:2048 sc1 lds
  s_add_u32 m0, s44, 57344
  s_nop 0
  buffer_load_dwordx4 v8, s[84:87], s42 offen lds
  buffer_load_dwordx4 v9, s[84:87], s42 offen offset:1024 lds
  buffer_load_dwordx4 v10, s[84:87], s42 offen offset:2048 lds
  buffer_load_dwordx4 v11, s[84:87], s42 offen offset:3072 lds
  s_waitcnt vmcnt(14)
  s_barrier
  s_add_u32 s45, s40, 3
  s_and_b32 s45, s45, 3
  s_and_b32 s46, s40, 4
  s_xor_b32 s46, s46, 4
  s_or_b32 s45, s45, s46
  s_lshl_b32 s45, s45, 1
  s_add_u32 s45, s45, 1
  s_lshl_b32 s42, s45, 17
  s_mul_i32 s41, s45, 12288
  s_add_u32 s41, s41, s49
  s_add_u32 m0, s43, 86016
  s_nop 0
  buffer_load_dwordx4 v1, s[32:35], s41 offen sc1 lds
  buffer_load_dwordx4 v1, s[32:35], s41 offen offset:1024 sc1 lds
  buffer_load_dwordx4 v1, s[32:35], s41 offen offset:2048 sc1 lds
  s_add_u32 m0, s44, 86016
  s_nop 0
  buffer_load_dwordx4 v8, s[84:87], s42 offen lds
  buffer_load_dwordx4 v9, s[84:87], s42 offen offset:1024 lds
  buffer_load_dwordx4 v10, s[84:87], s42 offen offset:2048 lds
  buffer_load_dwordx4 v11, s[84:87], s42 offen offset:3072 lds
  s_waitcnt vmcnt(14)
  s_barrier
  s_waitcnt vmcnt(7)
  s_barrier
  s_waitcnt vmcnt(0)
  s_barrier
  s_barrier
L_end:
  s_endpgm
L_codeend:
.section .rodata,"a"
.p2align 6
.amdhsa_kernel standalone__mha_block_cached__near_ridge_kernel
  .amdhsa_next_free_vgpr 256
  .amdhsa_next_free_sgpr 102
  .amdhsa_accum_offset 256
  .amdhsa_group_segment_fixed_size 0
  .amdhsa_kernarg_size 64
  .amdhsa_user_sgpr_count 2
  .amdhsa_user_sgpr_kernarg_segment_ptr 1
  .amdhsa_system_sgpr_workgroup_id_x 1
.end_amdhsa_kernel
```
